```python
import torch

def _softmax(x, axis=-1):
    return torch.softmax(x, dim=axis)
def _gelu(x):
    return torch.nn.functional.gelu(x, approximate="tanh")
def _silu(x):
    return torch.nn.functional.silu(x)
def _sigmoid(x):
    return torch.sigmoid(x)
def _layernorm(x, axis=-1, eps=1e-5):
    m = x.mean(dim=axis, keepdim=True)
    v = x.var(dim=axis, keepdim=True, unbiased=False)
    return (x - m) / torch.sqrt(v + eps)
def _scatter_add(tgt, idx, src, axis=0):
    return tgt.clone().index_add_(axis, idx, src)
def _segment_sum(src, seg, n):
    out = torch.zeros((n,) + src.shape[1:], dtype=src.dtype)
    return out.index_add_(0, seg, src)
def _pad(x, pw):
    flat = tuple(v for pair in reversed(pw) for v in pair)
    return torch.nn.functional.pad(x, flat)

kernel_name = 'concat_heads__sliding_block_cached__gqa_block_cached__decode'

def setup_inputs():

    _w = (lambda a: (lambda t: t.to(torch.bfloat16) if t.is_floating_point() else t)(torch.as_tensor(a)))
    def _A_setup():
        B, Sq, D = 1, 1, 640
        Hq, Hkv, Sk, Dh = 32, 32, 4096, 128
        assert Hq % Hkv == 0, (Hq, Hkv)
        return {
            "x": _w((lambda *s: torch.randn(*s, dtype=torch.bfloat16) * 0.2)(B, Sq, D)),
            "k_cache": _w((lambda *s: torch.randn(*s, dtype=torch.bfloat16) * 3.2)(B, Hkv, Sk, Dh)),
            "v_cache": _w((lambda *s: torch.randn(*s, dtype=torch.bfloat16) * 1.6)(B, Hkv, Sk, Dh)),
            "wq": _w((lambda *s: torch.randn(*s, dtype=torch.bfloat16) * 3.2)(D, Hq * Dh) * (D ** -0.5)),
            "wo": _w((lambda *s: torch.randn(*s, dtype=torch.bfloat16) * 1.6)(Hq * Dh, D) * ((Hq * Dh) ** -0.5)),
        }
    _A_in = _A_setup()

    def _B_setup():
        B, Sq, D = 1, 1, 640
        Hq, Hkv, Sk, Dh = 32, 32, 4096, 128
        assert Hq % Hkv == 0, (Hq, Hkv)
        return {
            "x": _w((lambda *s: torch.randn(*s, dtype=torch.bfloat16) * 0.4)(B, Sq, D)),
            "k_cache": _w((lambda *s: torch.randn(*s, dtype=torch.bfloat16) * 3.2)(B, Hkv, Sk, Dh)),
            "v_cache": _w((lambda *s: torch.randn(*s, dtype=torch.bfloat16) * 0.8)(B, Hkv, Sk, Dh)),
            "wq": _w((lambda *s: torch.randn(*s, dtype=torch.bfloat16) * 3.2)(D, Hq * Dh) * (D ** -0.5)),
            "wo": _w((lambda *s: torch.randn(*s, dtype=torch.bfloat16) * 0.8)(Hq * Dh, D) * ((Hq * Dh) ** -0.5)),
        }
    _B_in = _B_setup()

    return {
        "A_x": _A_in["x"],
        "A_k_cache": _A_in["k_cache"],
        "A_v_cache": _A_in["v_cache"],
        "A_wq": _A_in["wq"],
        "A_wo": _A_in["wo"],
        "B_x": _B_in["x"],
        "B_k_cache": _B_in["k_cache"],
        "B_v_cache": _B_in["v_cache"],
        "B_wq": _B_in["wq"],
        "B_wo": _B_in["wo"],
    }

def reference(A_x, A_k_cache, A_v_cache, A_wq, A_wo, B_x, B_k_cache, B_v_cache, B_wq, B_wo):
    def _A_ref(x, k_cache, v_cache, wq, wo):
        B, Sq, D = x.shape
        Hq, Dh = 32, 128
        Hkv, Sk = k_cache.shape[1], k_cache.shape[2]
        W = min(4096, max(256, Sk // 4))
        rep = Hq // Hkv
        q = (lambda x, *d: x.permute(*d))((x @ wq).reshape(B, Sq, Hq, Dh), 0, 2, 1, 3)
        k = (lambda x, n, axis: torch.repeat_interleave(x, n, dim=axis))(k_cache[:, :, Sk - W:, :], rep, axis=1)
        v = (lambda x, n, axis: torch.repeat_interleave(x, n, dim=axis))(v_cache[:, :, Sk - W:, :], rep, axis=1)
        scores = torch.einsum("bhqd,bhkd->bhqk", q, k) * (Dh ** -0.5)
        p = _softmax(scores, axis=-1)
        o = torch.einsum("bhqk,bhkd->bhqd", p, v)
        return (lambda x, *d: x.permute(*d))(o, 0, 2, 1, 3).reshape(B, Sq, Hq * Dh) @ wo

    def _B_ref(x, k_cache, v_cache, wq, wo):
        B, Sq, D = x.shape
        Hq, Dh = 32, 128
        Hkv = k_cache.shape[1]
        rep = Hq // Hkv
        q = (lambda x, *d: x.permute(*d))((x @ wq).reshape(B, Sq, Hq, Dh), 0, 2, 1, 3)
        k = (lambda x, n, axis: torch.repeat_interleave(x, n, dim=axis))(k_cache, rep, axis=1)
        v = (lambda x, n, axis: torch.repeat_interleave(x, n, dim=axis))(v_cache, rep, axis=1)
        scores = torch.einsum("bhqd,bhkd->bhqk", q, k) * (Dh ** -0.5)
        p = _softmax(scores, axis=-1)
        o = torch.einsum("bhqk,bhkd->bhqd", p, v)
        return (lambda x, *d: x.permute(*d))(o, 0, 2, 1, 3).reshape(B, Sq, Hq * Dh) @ wo

    a = _A_ref(A_x, A_k_cache, A_v_cache, A_wq, A_wo)
    b = _B_ref(B_x, B_k_cache, B_v_cache, B_wq, B_wo)
    return torch.concatenate([a, b], axis=-1)
```

```asm
; @launch grid=(256,1,1) block=(512,1,1) lds=36864
.amdgcn_target "amdgcn-amd-amdhsa--gfx950"
.text
.globl concat_heads__sliding_block_cached__gqa_block_cached__decode_kernel
.p2align 8
.type concat_heads__sliding_block_cached__gqa_block_cached__decode_kernel,@function
concat_heads__sliding_block_cached__gqa_block_cached__decode_kernel:
    s_cmp_ge_u32 s2, 256
    s_cbranch_scc1 L_end2
    s_load_dwordx16 s[16:31], s[0:1], 0
    s_load_dwordx8 s[32:39], s[0:1], 64
    s_load_dwordx2 s[40:41], s[0:1], 96

    s_and_b32 s3, s2, 7
    s_lshr_b32 s4, s2, 3
    v_lshrrev_b32 v1, 6, v0
    v_and_b32 v0, 0x3ff, v0
    v_readfirstlane_b32 s11, v1
    v_and_b32 v1, 63, v0
    v_and_b32 v2, 15, v1
    v_lshrrev_b32 v3, 4, v1
    s_mul_i32 s5, s4, 43
    s_lshr_b32 s5, s5, 8
    s_mul_i32 s6, s5, 6
    s_sub_u32 s6, s4, s6
    s_cmp_lt_u32 s6, 4
    s_cselect_b32 s7, 43, 42
    s_mul_i32 s8, s6, 43
    s_max_u32 s76, s6, 4
    s_sub_u32 s76, s76, 4
    s_sub_u32 s8, s8, s76
    s_lshl_b32 s8, s8, 4
    s_sub_u32 s77, s4, 24
    s_lshr_b32 s78, s77, 1
    s_and_b32 s79, s77, 1
    s_lshl_b32 s80, s79, 9
    s_add_u32 s80, s80, 3072
    s_cmp_lt_u32 s4, 24
    s_cselect_b32 s5, s5, s78
    s_cselect_b32 s6, s6, s79
    s_cselect_b32 s7, s7, 32
    s_cselect_b32 s8, s8, s80
    s_cselect_b32 s12, 1, 0
    s_add_u32 s9, s3, 0
    s_and_b32 s9, s9, 7
    s_lshl_b32 s9, s9, 1
    s_and_b32 s76, s5, 1
    s_add_u32 s9, s9, s76
    s_lshr_b32 s76, s5, 1
    s_lshl_b32 s76, s76, 4
    s_add_u32 s9, s9, s76
    s_mul_i32 s10, s9, 6
    s_add_u32 s10, s10, s6
    s_lshl_b32 s76, s9, 1
    s_add_u32 s76, s76, s6
    s_add_u32 s76, s76, 192
    s_cmp_eq_u32 s12, 1
    s_cselect_b32 s10, s10, s76
    s_and_b32 s15, s6, 3
    s_lshl_b32 s77, s6, 1
    s_cmp_eq_u32 s12, 1
    s_cselect_b32 s15, s15, s77
    s_cselect_b32 s94, 48, 16
    s_cselect_b32 s96, 5, 1
    s_lshl_b32 s14, s94, 15
    s_lshl_b32 s94, s94, 3
    s_sub_u32 s95, s10, s6
    s_sub_u32 s99, s2, 0

    s_mov_b32 s80, 0x00ff00ff
    s_mov_b32 s81, 0x00ff00ff
    s_mov_b32 s82, 0x3e0293ee
    s_mov_b32 s84, 0x00010001
    s_mov_b32 s85, 0x00010001
    s_mov_b32 s55, 0x00020000
    s_mov_b32 s59, 0x00020000
    s_mov_b32 s63, 0x00020000
    s_mov_b32 s67, 0x00020000
    s_mov_b32 s71, 0x00020000
    s_mov_b32 s75, 0x00020000
    s_mov_b32 s70, 1280
    s_mov_b32 s66, 163840
    s_mov_b32 s74, 950528
    s_lshl_b32 s58, s7, 12
    s_mov_b32 s62, s58
    s_lshl_b32 s76, s6, 3
    s_add_u32 s76, s76, s11
    s_lshl_b32 s77, s76, 3
    v_lshlrev_b32 v10, 1, v3
    v_add_u32 v10, s77, v10
    s_lshl_b32 s76, s76, 15
    v_lshlrev_b32 v60, 13, v3
    v_lshl_add_u32 v60, v2, 4, v60
    v_add_u32 v60, s76, v60
    s_lshl_b32 s78, s9, 8
    s_sub_u32 s54, 5242880, s78
    s_add_u32 s77, s9, s5
    s_lshr_b32 s78, s9, 3
    s_add_u32 s77, s77, s78
    s_add_u32 s77, s77, s6
    s_add_u32 s77, s77, s11
    s_and_b32 s77, s77, 7
    s_lshr_b32 s78, s7, 3
    s_and_b32 s79, s7, 7
    s_mul_i32 s83, s77, s78
    s_min_u32 s79, s77, s79
    s_add_u32 s83, s83, s79
    s_lshl_b32 s83, s83, 12
    s_sub_u32 s97, s7, s77
    s_add_u32 s97, s97, 7
    s_lshr_b32 s97, s97, 3
    v_lshrrev_b32 v61, 2, v2
    v_lshlrev_b32 v61, 8, v61
    v_lshl_add_u32 v61, v3, 6, v61
    v_and_b32 v62, 3, v2
    v_lshl_add_u32 v61, v62, 4, v61
    s_lshl_b32 s78, s9, 8
    s_waitcnt lgkmcnt(0)
    s_cmp_eq_u32 s12, 1
    s_cselect_b64 s[48:49], s[32:33], s[22:23]
    s_cselect_b64 s[68:69], s[26:27], s[16:17]
    s_cselect_b64 s[44:45], s[28:29], s[18:19]
    s_cselect_b64 s[46:47], s[30:31], s[20:21]
    s_cselect_b64 s[50:51], s[34:35], s[24:25]
    s_add_u32 s52, s48, s78
    s_addc_u32 s53, s49, 0
    s_mov_b32 s72, s40
    s_mov_b32 s73, s41
    s_load_dword s42, s[40:41], 950272
    s_mov_b32 s76, 0
    buffer_load_dwordx4 v[80:83], v60, s[52:55], s76 offen
    s_add_u32 s76, s76, s14
    buffer_load_dwordx4 v[84:87], v60, s[52:55], s76 offen
    s_add_u32 s76, s76, s14
    buffer_load_dwordx4 v[88:91], v60, s[52:55], s76 offen
    s_add_u32 s76, s76, s14
    buffer_load_dwordx4 v[92:95], v60, s[52:55], s76 offen
    s_add_u32 s76, s76, s14
    s_cmp_eq_u32 s12, 1
    s_cbranch_scc1 L_wq4
    buffer_load_dwordx4 v[96:99], v60, s[52:55], s76 offen
    s_add_u32 s76, s76, s14
    buffer_load_dwordx4 v[100:103], v60, s[52:55], s76 offen
    s_add_u32 s76, s76, s14
    buffer_load_dwordx4 v[104:107], v60, s[52:55], s76 offen
    s_add_u32 s76, s76, s14
    buffer_load_dwordx4 v[108:111], v60, s[52:55], s76 offen
    s_add_u32 s76, s76, s14
    buffer_load_dwordx4 v[112:115], v60, s[52:55], s76 offen
    s_add_u32 s76, s76, s14
    buffer_load_dwordx4 v[116:119], v60, s[52:55], s76 offen
    s_add_u32 s76, s76, s14
L_wq4:
    s_mov_b32 s76, 0
    buffer_load_ushort v20, v10, s[68:71], s76 offen
    s_add_u32 s76, s76, s94
    buffer_load_ushort v21, v10, s[68:71], s76 offen
    s_add_u32 s76, s76, s94
    buffer_load_ushort v22, v10, s[68:71], s76 offen
    s_add_u32 s76, s76, s94
    buffer_load_ushort v23, v10, s[68:71], s76 offen
    s_add_u32 s76, s76, s94
    s_cmp_eq_u32 s12, 1
    s_cbranch_scc1 L_x4
    buffer_load_ushort v24, v10, s[68:71], s76 offen
    s_add_u32 s76, s76, s94
    buffer_load_ushort v25, v10, s[68:71], s76 offen
    s_add_u32 s76, s76, s94
    buffer_load_ushort v26, v10, s[68:71], s76 offen
    s_add_u32 s76, s76, s94
    buffer_load_ushort v27, v10, s[68:71], s76 offen
    s_add_u32 s76, s76, s94
    buffer_load_ushort v28, v10, s[68:71], s76 offen
    s_add_u32 s76, s76, s94
    buffer_load_ushort v29, v10, s[68:71], s76 offen
    s_add_u32 s76, s76, s94
L_x4:
    s_lshl_b32 s76, s9, 20
    s_lshl_b32 s77, s8, 8
    s_add_u32 s76, s76, s77
    s_add_u32 s56, s44, s76
    s_addc_u32 s57, s45, 0
    s_add_u32 s60, s46, s76
    s_addc_u32 s61, s47, 0
    s_mul_i32 s76, s9, 163840
    s_add_u32 s64, s50, s76
    s_addc_u32 s65, s51, 0
    s_lshl_b32 s76, s95, 9
    s_add_u32 s76, s76, 819200
    s_add_u32 s88, s40, s76
    s_addc_u32 s89, s41, 0
    s_add_u32 s90, s96, 1
    s_lshl_b32 s90, s90, 9
    s_mov_b32 s91, 0x00020000

    s_barrier
    s_mov_b32 s76, s83
    s_cmp_ge_u32 s11, 8
    s_cbranch_scc1 L_noek
    buffer_load_dwordx4 v[160:163], v61, s[56:59], s76 offen offset:0 nt
    buffer_load_dwordx4 v[164:167], v61, s[56:59], s76 offen offset:1024 nt
    buffer_load_dwordx4 v[168:171], v61, s[56:59], s76 offen offset:2048 nt
    buffer_load_dwordx4 v[172:175], v61, s[56:59], s76 offen offset:3072 nt
    s_add_u32 s76, s76, 4096
    buffer_load_dwordx4 v[176:179], v61, s[56:59], s76 offen offset:0 nt
    buffer_load_dwordx4 v[180:183], v61, s[56:59], s76 offen offset:1024 nt
    buffer_load_dwordx4 v[184:187], v61, s[56:59], s76 offen offset:2048 nt
    buffer_load_dwordx4 v[188:191], v61, s[56:59], s76 offen offset:3072 nt
L_noek:
    v_lshlrev_b32 v62, 4, v1
    s_mul_i32 s76, s11, 5120
    v_mul_u32_u24 v63, 1280, v3
    v_lshl_add_u32 v63, v2, 4, v63
    v_add_u32 v63, s76, v63
    v_and_b32 v12, 1, v2
    v_cmp_eq_u32 vcc, 1, v12
    v_mov_b32 v45, 0x0c0c0100
    v_mov_b32 v46, 0x01000c0c
    v_mov_b32 v47, 0x0c0c0302
    v_mov_b32 v48, 0x03020c0c
    v_cndmask_b32 v45, v45, v46, vcc
    v_cndmask_b32 v47, v47, v48, vcc
    v_lshrrev_b32 v44, 1, v2
    v_mov_b32 v46, 0x0c0c0c0c
    v_cmp_eq_u32 vcc, 0, v44
    s_nop 1
    v_cndmask_b32 v12, v46, v45, vcc
    v_cndmask_b32 v16, v46, v47, vcc
    v_cmp_eq_u32 vcc, 1, v44
    s_nop 1
    v_cndmask_b32 v13, v46, v45, vcc
    v_cndmask_b32 v17, v46, v47, vcc
    v_cmp_eq_u32 vcc, 2, v44
    s_nop 1
    v_cndmask_b32 v14, v46, v45, vcc
    v_cndmask_b32 v18, v46, v47, vcc
    v_cmp_eq_u32 vcc, 3, v44
    s_nop 1
    v_cndmask_b32 v15, v46, v45, vcc
    v_cndmask_b32 v19, v46, v47, vcc
    v_and_b32 v44, 7, v2
    v_mul_u32_u24 v44, 528, v44
    v_lshl_add_u32 v44, v3, 2, v44
    s_lshl_b32 s76, s11, 4
    v_add_u32 v44, s76, v44
    s_add_u32 s76, s15, 0
    s_and_b32 s76, s76, 3
    s_lshl_b32 s76, s76, 7
    v_add_u32 v68, s76, v44
    s_add_u32 s76, s15, 1
    s_and_b32 s76, s76, 3
    s_lshl_b32 s76, s76, 7
    v_add_u32 v69, s76, v44
    s_add_u32 s76, s15, 2
    s_and_b32 s76, s76, 3
    s_lshl_b32 s76, s76, 7
    v_add_u32 v70, s76, v44
    s_add_u32 s76, s15, 3
    s_and_b32 s76, s76, 3
    s_lshl_b32 s76, s76, 7
    v_add_u32 v71, s76, v44
    s_cmp_ge_u32 s11, 8
    s_cbranch_scc1 L_w0
    s_waitcnt vmcnt(8)
    s_branch L_w1
L_w0:
    s_waitcnt vmcnt(0)
L_w1:
    v_perm_b32 v44, v20, v20, v12
    v_perm_b32 v45, v20, v20, v13
    v_perm_b32 v46, v20, v20, v14
    v_perm_b32 v47, v20, v20, v15
    v_perm_b32 v48, v21, v21, v12
    v_perm_b32 v49, v21, v21, v13
    v_perm_b32 v50, v21, v21, v14
    v_perm_b32 v51, v21, v21, v15
    v_mfma_f32_16x16x32_bf16 v[52:55], v[80:83], v[44:47], 0
    v_perm_b32 v44, v22, v22, v12
    v_perm_b32 v45, v22, v22, v13
    v_perm_b32 v46, v22, v22, v14
    v_perm_b32 v47, v22, v22, v15
    v_mfma_f32_16x16x32_bf16 v[52:55], v[84:87], v[48:51], v[52:55]
    v_perm_b32 v48, v23, v23, v12
    v_perm_b32 v49, v23, v23, v13
    v_perm_b32 v50, v23, v23, v14
    v_perm_b32 v51, v23, v23, v15
    v_mfma_f32_16x16x32_bf16 v[52:55], v[88:91], v[44:47], v[52:55]
    s_nop 1
    v_mfma_f32_16x16x32_bf16 v[52:55], v[92:95], v[48:51], v[52:55]
    s_cmp_eq_u32 s12, 1
    s_cbranch_scc1 L_q4
    v_perm_b32 v44, v24, v24, v12
    v_perm_b32 v45, v24, v24, v13
    v_perm_b32 v46, v24, v24, v14
    v_perm_b32 v47, v24, v24, v15
    s_nop 1
    v_perm_b32 v48, v25, v25, v12
    v_perm_b32 v49, v25, v25, v13
    v_perm_b32 v50, v25, v25, v14
    v_perm_b32 v51, v25, v25, v15
    v_mfma_f32_16x16x32_bf16 v[52:55], v[96:99], v[44:47], v[52:55]
    v_perm_b32 v44, v26, v26, v12
    v_perm_b32 v45, v26, v26, v13
    v_perm_b32 v46, v26, v26, v14
    v_perm_b32 v47, v26, v26, v15
    v_mfma_f32_16x16x32_bf16 v[52:55], v[100:103], v[48:51], v[52:55]
    v_perm_b32 v48, v27, v27, v12
    v_perm_b32 v49, v27, v27, v13
    v_perm_b32 v50, v27, v27, v14
    v_perm_b32 v51, v27, v27, v15
    v_mfma_f32_16x16x32_bf16 v[52:55], v[104:107], v[44:47], v[52:55]
    v_perm_b32 v44, v28, v28, v12
    v_perm_b32 v45, v28, v28, v13
    v_perm_b32 v46, v28, v28, v14
    v_perm_b32 v47, v28, v28, v15
    v_mfma_f32_16x16x32_bf16 v[52:55], v[108:111], v[48:51], v[52:55]
    v_perm_b32 v48, v29, v29, v12
    v_perm_b32 v49, v29, v29, v13
    v_perm_b32 v50, v29, v29, v14
    v_perm_b32 v51, v29, v29, v15
    v_mfma_f32_16x16x32_bf16 v[52:55], v[112:115], v[44:47], v[52:55]
    s_nop 1
    v_mfma_f32_16x16x32_bf16 v[52:55], v[116:119], v[48:51], v[52:55]
L_q4:
    s_waitcnt lgkmcnt(0)
    s_add_u32 s42, s42, 1
    s_not_b32 s43, s42
    s_and_b32 s94, s42, 0xfff
    s_bfe_u32 s95, s42, 0xc000c
    s_lshr_b32 s96, s42, 24
    s_lshl_b32 s98, s42, 8
    s_or_b32 s96, s96, s98
    s_and_b32 s96, s96, 0xfff
    s_xor_b32 s98, s42, 0x5a5
    s_and_b32 s98, s98, 0xfff
    v_lshlrev_b32 v4, 3, v3
    v_add_u32 v4, v4, v2
    v_lshlrev_b32 v4, 4, v4
    s_lshl_b32 s76, s11, 9
    v_add_u32 v4, s76, v4
    s_nop 4
    s_mov_b64 exec, s[80:81]
    ds_write_b128 v4, v[52:55] offset:0
    s_mov_b64 exec, -1
    s_waitcnt lgkmcnt(0)
    s_barrier
    s_cmp_lg_u32 s11, 0
    s_cbranch_scc1 L_nopart
    v_lshlrev_b32 v8, 4, v1
    v_mov_b32 v11, 0xfff
    s_mov_b64 exec, 0xffffffff
    ds_read_b128 v[20:23], v8 offset:0
    ds_read_b128 v[24:27], v8 offset:512
    ds_read_b128 v[28:31], v8 offset:1024
    ds_read_b128 v[32:35], v8 offset:1536
    ds_read_b128 v[36:39], v8 offset:2048
    ds_read_b128 v[40:43], v8 offset:2560
    ds_read_b128 v[44:47], v8 offset:3072
    ds_read_b128 v[48:51], v8 offset:3584
    s_waitcnt lgkmcnt(0)
    v_add_f32 v20, v20, v24
    v_add_f32 v28, v28, v32
    v_add_f32 v36, v36, v40
    v_add_f32 v44, v44, v48
    v_add_f32 v21, v21, v25
    v_add_f32 v29, v29, v33
    v_add_f32 v37, v37, v41
    v_add_f32 v45, v45, v49
    v_add_f32 v22, v22, v26
    v_add_f32 v30, v30, v34
    v_add_f32 v38, v38, v42
    v_add_f32 v46, v46, v50
    v_add_f32 v23, v23, v27
    v_add_f32 v31, v31, v35
    v_add_f32 v39, v39, v43
    v_add_f32 v47, v47, v51
    v_add_f32 v20, v20, v28
    v_add_f32 v36, v36, v44
    v_add_f32 v21, v21, v29
    v_add_f32 v37, v37, v45
    v_add_f32 v22, v22, v30
    v_add_f32 v38, v38, v46
    v_add_f32 v23, v23, v31
    v_add_f32 v39, v39, v47
    v_add_f32 v20, v20, v36
    v_add_f32 v21, v21, v37
    v_add_f32 v22, v22, v38
    v_add_f32 v23, v23, v39
    v_bfi_b32 v20, v11, s94, v20
    v_bfi_b32 v21, v11, s95, v21
    v_bfi_b32 v22, v11, s96, v22
    v_bfi_b32 v23, v11, s98, v23
    s_lshl_b32 s76, s10, 9
    s_add_u32 s76, s76, 819200
    buffer_store_dwordx4 v[20:23], v8, s[72:75], s76 offen sc1
    s_mov_b64 exec, -1
L_nopart:
    s_cmp_eq_u32 s97, 6
    s_cbranch_scc1 L6_start
    s_cmp_eq_u32 s97, 5
    s_cbranch_scc1 L5_start
L4_start:
    s_add_u32 s76, s83, 8192
    buffer_load_dwordx4 v[192:195], v61, s[56:59], s76 offen offset:0 nt
    buffer_load_dwordx4 v[196:199], v61, s[56:59], s76 offen offset:1024 nt
    buffer_load_dwordx4 v[200:203], v61, s[56:59], s76 offen offset:2048 nt
    buffer_load_dwordx4 v[204:207], v61, s[56:59], s76 offen offset:3072 nt
    s_add_u32 s76, s76, 4096
    buffer_load_dwordx4 v[208:211], v61, s[56:59], s76 offen offset:0 nt
    buffer_load_dwordx4 v[212:215], v61, s[56:59], s76 offen offset:1024 nt
    buffer_load_dwordx4 v[216:219], v61, s[56:59], s76 offen offset:2048 nt
    buffer_load_dwordx4 v[220:223], v61, s[56:59], s76 offen offset:3072 nt
    s_cmp_eq_u32 s11, 0
    s_cbranch_scc1 L4_poll
    s_add_u32 s76, s15, 0
    s_and_b32 s76, s76, 3
    s_mul_i32 s76, s76, 40960
    buffer_load_dwordx4 v[80:83], v63, s[64:67], s76 offen offset:0
    buffer_load_dwordx4 v[84:87], v63, s[64:67], s76 offen offset:256
    buffer_load_dwordx4 v[88:91], v63, s[64:67], s76 offen offset:512
    buffer_load_dwordx4 v[92:95], v63, s[64:67], s76 offen offset:768
    buffer_load_dwordx4 v[96:99], v63, s[64:67], s76 offen offset:1024
    s_add_u32 s76, s15, 1
    s_and_b32 s76, s76, 3
    s_mul_i32 s76, s76, 40960
    buffer_load_dwordx4 v[100:103], v63, s[64:67], s76 offen offset:0
    buffer_load_dwordx4 v[104:107], v63, s[64:67], s76 offen offset:256
    buffer_load_dwordx4 v[108:111], v63, s[64:67], s76 offen offset:512
    buffer_load_dwordx4 v[112:115], v63, s[64:67], s76 offen offset:768
    buffer_load_dwordx4 v[116:119], v63, s[64:67], s76 offen offset:1024
    s_add_u32 s76, s15, 2
    s_and_b32 s76, s76, 3
    s_mul_i32 s76, s76, 40960
    buffer_load_dwordx4 v[120:123], v63, s[64:67], s76 offen offset:0
    buffer_load_dwordx4 v[124:127], v63, s[64:67], s76 offen offset:256
    buffer_load_dwordx4 v[128:131], v63, s[64:67], s76 offen offset:512
    buffer_load_dwordx4 v[132:135], v63, s[64:67], s76 offen offset:768
    buffer_load_dwordx4 v[136:139], v63, s[64:67], s76 offen offset:1024
    s_add_u32 s76, s15, 3
    s_and_b32 s76, s76, 3
    s_mul_i32 s76, s76, 40960
    buffer_load_dwordx4 v[140:143], v63, s[64:67], s76 offen offset:0
    buffer_load_dwordx4 v[144:147], v63, s[64:67], s76 offen offset:256
    buffer_load_dwordx4 v[148:151], v63, s[64:67], s76 offen offset:512
    buffer_load_dwordx4 v[152:155], v63, s[64:67], s76 offen offset:768
    buffer_load_dwordx4 v[156:159], v63, s[64:67], s76 offen offset:1024
    s_branch L4_bar2
L4_poll:
    v_lshlrev_b32 v8, 4, v1
    s_mov_b64 exec, 0xffffffff
L4_fok:
    buffer_load_dwordx4 v[20:23], v8, s[88:91], 0 offen offset:0 sc1
    buffer_load_dwordx4 v[24:27], v8, s[88:91], 0 offen offset:512 sc1
    s_cmp_eq_u32 s12, 0
    s_cbranch_scc1 L4_pA
    buffer_load_dwordx4 v[28:31], v8, s[88:91], 0 offen offset:1024 sc1
    buffer_load_dwordx4 v[32:35], v8, s[88:91], 0 offen offset:1536 sc1
    buffer_load_dwordx4 v[36:39], v8, s[88:91], 0 offen offset:2048 sc1
    buffer_load_dwordx4 v[40:43], v8, s[88:91], 0 offen offset:2560 sc1
    s_waitcnt vmcnt(0)
    v_xor_b32 v44, s94, v20
    v_xor_b32 v45, s95, v21
    v_xor_b32 v46, s96, v22
    v_xor_b32 v47, s98, v23
    v_or3_b32 v7, v44, v45, v46
    v_or_b32 v7, v7, v47
    v_xor_b32 v44, s94, v24
    v_xor_b32 v45, s95, v25
    v_xor_b32 v46, s96, v26
    v_xor_b32 v47, s98, v27
    v_or3_b32 v7, v7, v44, v45
    v_or3_b32 v7, v7, v46, v47
    v_xor_b32 v44, s94, v28
    v_xor_b32 v45, s95, v29
    v_xor_b32 v46, s96, v30
    v_xor_b32 v47, s98, v31
    v_or3_b32 v7, v7, v44, v45
    v_or3_b32 v7, v7, v46, v47
    v_xor_b32 v44, s94, v32
    v_xor_b32 v45, s95, v33
    v_xor_b32 v46, s96, v34
    v_xor_b32 v47, s98, v35
    v_or3_b32 v7, v7, v44, v45
    v_or3_b32 v7, v7, v46, v47
    v_xor_b32 v44, s94, v36
    v_xor_b32 v45, s95, v37
    v_xor_b32 v46, s96, v38
    v_xor_b32 v47, s98, v39
    v_or3_b32 v7, v7, v44, v45
    v_or3_b32 v7, v7, v46, v47
    v_xor_b32 v44, s94, v40
    v_xor_b32 v45, s95, v41
    v_xor_b32 v46, s96, v42
    v_xor_b32 v47, s98, v43
    v_or3_b32 v7, v7, v44, v45
    v_or3_b32 v7, v7, v46, v47
    v_and_b32 v7, 0xfff, v7
    v_cmp_ne_u32 vcc, 0, v7
    s_cbranch_vccz L4_qokB
    s_sleep 2
    s_branch L4_fok
L4_qokB:
    v_add_f32 v20, v20, v24
    v_add_f32 v28, v28, v32
    v_add_f32 v36, v36, v40
    v_add_f32 v21, v21, v25
    v_add_f32 v29, v29, v33
    v_add_f32 v37, v37, v41
    v_add_f32 v22, v22, v26
    v_add_f32 v30, v30, v34
    v_add_f32 v38, v38, v42
    v_add_f32 v23, v23, v27
    v_add_f32 v31, v31, v35
    v_add_f32 v39, v39, v43
    v_add_f32 v20, v20, v28
    v_add_f32 v21, v21, v29
    v_add_f32 v22, v22, v30
    v_add_f32 v23, v23, v31
    v_add_f32 v20, v20, v36
    v_add_f32 v21, v21, v37
    v_add_f32 v22, v22, v38
    v_add_f32 v23, v23, v39
    s_branch L4_qsum
L4_pA:
    s_waitcnt vmcnt(0)
    v_xor_b32 v44, s94, v20
    v_xor_b32 v45, s95, v21
    v_xor_b32 v46, s96, v22
    v_xor_b32 v47, s98, v23
    v_or3_b32 v7, v44, v45, v46
    v_or_b32 v7, v7, v47
    v_xor_b32 v44, s94, v24
    v_xor_b32 v45, s95, v25
    v_xor_b32 v46, s96, v26
    v_xor_b32 v47, s98, v27
    v_or3_b32 v7, v7, v44, v45
    v_or3_b32 v7, v7, v46, v47
    v_and_b32 v7, 0xfff, v7
    v_cmp_ne_u32 vcc, 0, v7
    s_cbranch_vccz L4_qokA
    s_sleep 2
    s_branch L4_fok
L4_qokA:
    v_add_f32 v20, v20, v24
    v_add_f32 v21, v21, v25
    v_add_f32 v22, v22, v26
    v_add_f32 v23, v23, v27
L4_qsum:
    v_cvt_pk_bf16_f32 v20, v20, v21
    v_cvt_pk_bf16_f32 v22, v22, v23
    v_lshrrev_b32 v6, 3, v1
    v_lshlrev_b32 v6, 6, v6
    v_and_b32 v7, 7, v1
    v_lshl_add_u32 v6, v7, 1, v6
    ds_write_b16 v6, v20 offset:4096
    ds_write_b16_d16_hi v6, v20 offset:4112
    ds_write_b16 v6, v22 offset:4128
    ds_write_b16_d16_hi v6, v22 offset:4144
    s_mov_b64 exec, -1
    s_waitcnt lgkmcnt(0)
L4_bar2:
    s_barrier
    v_and_b32 v4, 3, v2
    v_lshl_add_u32 v4, v3, 2, v4
    v_lshlrev_b32 v4, 4, v4
    ds_read_b128 v[44:47], v4 offset:4096
    s_cmp_lg_u32 s11, 0
    s_cbranch_scc1 L4_wodone
    s_add_u32 s76, s15, 0
    s_and_b32 s76, s76, 3
    s_mul_i32 s76, s76, 40960
    buffer_load_dwordx4 v[80:83], v63, s[64:67], s76 offen offset:0
    buffer_load_dwordx4 v[84:87], v63, s[64:67], s76 offen offset:256
    buffer_load_dwordx4 v[88:91], v63, s[64:67], s76 offen offset:512
    buffer_load_dwordx4 v[92:95], v63, s[64:67], s76 offen offset:768
    buffer_load_dwordx4 v[96:99], v63, s[64:67], s76 offen offset:1024
    s_add_u32 s76, s15, 1
    s_and_b32 s76, s76, 3
    s_mul_i32 s76, s76, 40960
    buffer_load_dwordx4 v[100:103], v63, s[64:67], s76 offen offset:0
    buffer_load_dwordx4 v[104:107], v63, s[64:67], s76 offen offset:256
    buffer_load_dwordx4 v[108:111], v63, s[64:67], s76 offen offset:512
    buffer_load_dwordx4 v[112:115], v63, s[64:67], s76 offen offset:768
    buffer_load_dwordx4 v[116:119], v63, s[64:67], s76 offen offset:1024
    s_add_u32 s76, s15, 2
    s_and_b32 s76, s76, 3
    s_mul_i32 s76, s76, 40960
    buffer_load_dwordx4 v[120:123], v63, s[64:67], s76 offen offset:0
    buffer_load_dwordx4 v[124:127], v63, s[64:67], s76 offen offset:256
    buffer_load_dwordx4 v[128:131], v63, s[64:67], s76 offen offset:512
    buffer_load_dwordx4 v[132:135], v63, s[64:67], s76 offen offset:768
    buffer_load_dwordx4 v[136:139], v63, s[64:67], s76 offen offset:1024
    s_add_u32 s76, s15, 3
    s_and_b32 s76, s76, 3
    s_mul_i32 s76, s76, 40960
    buffer_load_dwordx4 v[140:143], v63, s[64:67], s76 offen offset:0
    buffer_load_dwordx4 v[144:147], v63, s[64:67], s76 offen offset:256
    buffer_load_dwordx4 v[148:151], v63, s[64:67], s76 offen offset:512
    buffer_load_dwordx4 v[152:155], v63, s[64:67], s76 offen offset:768
    buffer_load_dwordx4 v[156:159], v63, s[64:67], s76 offen offset:1024
L4_wodone:
    s_waitcnt lgkmcnt(0)
    s_mov_b32 s76, s83
    s_waitcnt vmcnt(32)
    v_mfma_f32_16x16x32_bf16 v[48:51], v[160:163], v[44:47], 0
    v_mfma_f32_16x16x32_bf16 v[52:55], v[164:167], v[44:47], 0
    v_mfma_f32_16x16x32_bf16 v[56:59], v[168:171], v[44:47], 0
    v_mfma_f32_16x16x32_bf16 v[76:79], v[172:175], v[44:47], 0
    buffer_load_dwordx4 v[160:163], v62, s[60:63], s76 offen offset:0 nt
    buffer_load_dwordx4 v[164:167], v62, s[60:63], s76 offen offset:1024 nt
    buffer_load_dwordx4 v[168:171], v62, s[60:63], s76 offen offset:2048 nt
    buffer_load_dwordx4 v[172:175], v62, s[60:63], s76 offen offset:3072 nt
    s_nop 1
    v_mov_b32_dpp v20, v48 quad_perm:[0,0,0,0] row_mask:0xf bank_mask:0xf
    v_mov_b32_dpp v21, v52 quad_perm:[0,0,0,0] row_mask:0xf bank_mask:0xf
    v_mov_b32_dpp v22, v56 quad_perm:[0,0,0,0] row_mask:0xf bank_mask:0xf
    v_mov_b32_dpp v23, v76 quad_perm:[0,0,0,0] row_mask:0xf bank_mask:0xf
    v_add_f32_dpp v20, v49, v20 quad_perm:[1,1,1,1] row_mask:0xf bank_mask:0xf
    v_add_f32_dpp v21, v53, v21 quad_perm:[1,1,1,1] row_mask:0xf bank_mask:0xf
    v_add_f32_dpp v22, v57, v22 quad_perm:[1,1,1,1] row_mask:0xf bank_mask:0xf
    v_add_f32_dpp v23, v77, v23 quad_perm:[1,1,1,1] row_mask:0xf bank_mask:0xf
    v_add_f32_dpp v20, v50, v20 quad_perm:[2,2,2,2] row_mask:0xf bank_mask:0xf
    v_add_f32_dpp v21, v54, v21 quad_perm:[2,2,2,2] row_mask:0xf bank_mask:0xf
    v_add_f32_dpp v22, v58, v22 quad_perm:[2,2,2,2] row_mask:0xf bank_mask:0xf
    v_add_f32_dpp v23, v78, v23 quad_perm:[2,2,2,2] row_mask:0xf bank_mask:0xf
    v_add_f32_dpp v20, v51, v20 quad_perm:[3,3,3,3] row_mask:0xf bank_mask:0xf
    v_add_f32_dpp v21, v55, v21 quad_perm:[3,3,3,3] row_mask:0xf bank_mask:0xf
    v_add_f32_dpp v22, v59, v22 quad_perm:[3,3,3,3] row_mask:0xf bank_mask:0xf
    v_add_f32_dpp v23, v79, v23 quad_perm:[3,3,3,3] row_mask:0xf bank_mask:0xf
    s_add_u32 s76, s76, 4096
    s_waitcnt vmcnt(32)
    v_mfma_f32_16x16x32_bf16 v[48:51], v[176:179], v[44:47], 0
    v_mfma_f32_16x16x32_bf16 v[52:55], v[180:183], v[44:47], 0
    v_mfma_f32_16x16x32_bf16 v[56:59], v[184:187], v[44:47], 0
    v_mfma_f32_16x16x32_bf16 v[76:79], v[188:191], v[44:47], 0
    buffer_load_dwordx4 v[176:179], v62, s[60:63], s76 offen offset:0 nt
    buffer_load_dwordx4 v[180:183], v62, s[60:63], s76 offen offset:1024 nt
    buffer_load_dwordx4 v[184:187], v62, s[60:63], s76 offen offset:2048 nt
    buffer_load_dwordx4 v[188:191], v62, s[60:63], s76 offen offset:3072 nt
    s_nop 1
    v_mov_b32_dpp v24, v48 quad_perm:[0,0,0,0] row_mask:0xf bank_mask:0xf
    v_mov_b32_dpp v25, v52 quad_perm:[0,0,0,0] row_mask:0xf bank_mask:0xf
    v_mov_b32_dpp v26, v56 quad_perm:[0,0,0,0] row_mask:0xf bank_mask:0xf
    v_mov_b32_dpp v27, v76 quad_perm:[0,0,0,0] row_mask:0xf bank_mask:0xf
    v_add_f32_dpp v24, v49, v24 quad_perm:[1,1,1,1] row_mask:0xf bank_mask:0xf
    v_add_f32_dpp v25, v53, v25 quad_perm:[1,1,1,1] row_mask:0xf bank_mask:0xf
    v_add_f32_dpp v26, v57, v26 quad_perm:[1,1,1,1] row_mask:0xf bank_mask:0xf
    v_add_f32_dpp v27, v77, v27 quad_perm:[1,1,1,1] row_mask:0xf bank_mask:0xf
    v_add_f32_dpp v24, v50, v24 quad_perm:[2,2,2,2] row_mask:0xf bank_mask:0xf
    v_add_f32_dpp v25, v54, v25 quad_perm:[2,2,2,2] row_mask:0xf bank_mask:0xf
    v_add_f32_dpp v26, v58, v26 quad_perm:[2,2,2,2] row_mask:0xf bank_mask:0xf
    v_add_f32_dpp v27, v78, v27 quad_perm:[2,2,2,2] row_mask:0xf bank_mask:0xf
    v_add_f32_dpp v24, v51, v24 quad_perm:[3,3,3,3] row_mask:0xf bank_mask:0xf
    v_add_f32_dpp v25, v55, v25 quad_perm:[3,3,3,3] row_mask:0xf bank_mask:0xf
    v_add_f32_dpp v26, v59, v26 quad_perm:[3,3,3,3] row_mask:0xf bank_mask:0xf
    v_add_f32_dpp v27, v79, v27 quad_perm:[3,3,3,3] row_mask:0xf bank_mask:0xf
    s_add_u32 s76, s76, 4096
    s_waitcnt vmcnt(32)
    v_mfma_f32_16x16x32_bf16 v[48:51], v[192:195], v[44:47], 0
    v_mfma_f32_16x16x32_bf16 v[52:55], v[196:199], v[44:47], 0
    v_mfma_f32_16x16x32_bf16 v[56:59], v[200:203], v[44:47], 0
    v_mfma_f32_16x16x32_bf16 v[76:79], v[204:207], v[44:47], 0
    buffer_load_dwordx4 v[192:195], v62, s[60:63], s76 offen offset:0 nt
    buffer_load_dwordx4 v[196:199], v62, s[60:63], s76 offen offset:1024 nt
    buffer_load_dwordx4 v[200:203], v62, s[60:63], s76 offen offset:2048 nt
    buffer_load_dwordx4 v[204:207], v62, s[60:63], s76 offen offset:3072 nt
    s_nop 1
    v_mov_b32_dpp v28, v48 quad_perm:[0,0,0,0] row_mask:0xf bank_mask:0xf
    v_mov_b32_dpp v29, v52 quad_perm:[0,0,0,0] row_mask:0xf bank_mask:0xf
    v_mov_b32_dpp v30, v56 quad_perm:[0,0,0,0] row_mask:0xf bank_mask:0xf
    v_mov_b32_dpp v31, v76 quad_perm:[0,0,0,0] row_mask:0xf bank_mask:0xf
    v_add_f32_dpp v28, v49, v28 quad_perm:[1,1,1,1] row_mask:0xf bank_mask:0xf
    v_add_f32_dpp v29, v53, v29 quad_perm:[1,1,1,1] row_mask:0xf bank_mask:0xf
    v_add_f32_dpp v30, v57, v30 quad_perm:[1,1,1,1] row_mask:0xf bank_mask:0xf
    v_add_f32_dpp v31, v77, v31 quad_perm:[1,1,1,1] row_mask:0xf bank_mask:0xf
    v_add_f32_dpp v28, v50, v28 quad_perm:[2,2,2,2] row_mask:0xf bank_mask:0xf
    v_add_f32_dpp v29, v54, v29 quad_perm:[2,2,2,2] row_mask:0xf bank_mask:0xf
    v_add_f32_dpp v30, v58, v30 quad_perm:[2,2,2,2] row_mask:0xf bank_mask:0xf
    v_add_f32_dpp v31, v78, v31 quad_perm:[2,2,2,2] row_mask:0xf bank_mask:0xf
    v_add_f32_dpp v28, v51, v28 quad_perm:[3,3,3,3] row_mask:0xf bank_mask:0xf
    v_add_f32_dpp v29, v55, v29 quad_perm:[3,3,3,3] row_mask:0xf bank_mask:0xf
    v_add_f32_dpp v30, v59, v30 quad_perm:[3,3,3,3] row_mask:0xf bank_mask:0xf
    v_add_f32_dpp v31, v79, v31 quad_perm:[3,3,3,3] row_mask:0xf bank_mask:0xf
    s_add_u32 s76, s76, 4096
    s_waitcnt vmcnt(32)
    v_mfma_f32_16x16x32_bf16 v[48:51], v[208:211], v[44:47], 0
    v_mfma_f32_16x16x32_bf16 v[52:55], v[212:215], v[44:47], 0
    v_mfma_f32_16x16x32_bf16 v[56:59], v[216:219], v[44:47], 0
    v_mfma_f32_16x16x32_bf16 v[76:79], v[220:223], v[44:47], 0
    buffer_load_dwordx4 v[208:211], v62, s[60:63], s76 offen offset:0 nt
    buffer_load_dwordx4 v[212:215], v62, s[60:63], s76 offen offset:1024 nt
    buffer_load_dwordx4 v[216:219], v62, s[60:63], s76 offen offset:2048 nt
    buffer_load_dwordx4 v[220:223], v62, s[60:63], s76 offen offset:3072 nt
    s_nop 1
    v_mov_b32_dpp v32, v48 quad_perm:[0,0,0,0] row_mask:0xf bank_mask:0xf
    v_mov_b32_dpp v33, v52 quad_perm:[0,0,0,0] row_mask:0xf bank_mask:0xf
    v_mov_b32_dpp v34, v56 quad_perm:[0,0,0,0] row_mask:0xf bank_mask:0xf
    v_mov_b32_dpp v35, v76 quad_perm:[0,0,0,0] row_mask:0xf bank_mask:0xf
    v_add_f32_dpp v32, v49, v32 quad_perm:[1,1,1,1] row_mask:0xf bank_mask:0xf
    v_add_f32_dpp v33, v53, v33 quad_perm:[1,1,1,1] row_mask:0xf bank_mask:0xf
    v_add_f32_dpp v34, v57, v34 quad_perm:[1,1,1,1] row_mask:0xf bank_mask:0xf
    v_add_f32_dpp v35, v77, v35 quad_perm:[1,1,1,1] row_mask:0xf bank_mask:0xf
    v_add_f32_dpp v32, v50, v32 quad_perm:[2,2,2,2] row_mask:0xf bank_mask:0xf
    v_add_f32_dpp v33, v54, v33 quad_perm:[2,2,2,2] row_mask:0xf bank_mask:0xf
    v_add_f32_dpp v34, v58, v34 quad_perm:[2,2,2,2] row_mask:0xf bank_mask:0xf
    v_add_f32_dpp v35, v78, v35 quad_perm:[2,2,2,2] row_mask:0xf bank_mask:0xf
    v_add_f32_dpp v32, v51, v32 quad_perm:[3,3,3,3] row_mask:0xf bank_mask:0xf
    v_add_f32_dpp v33, v55, v33 quad_perm:[3,3,3,3] row_mask:0xf bank_mask:0xf
    v_add_f32_dpp v34, v59, v34 quad_perm:[3,3,3,3] row_mask:0xf bank_mask:0xf
    v_add_f32_dpp v35, v79, v35 quad_perm:[3,3,3,3] row_mask:0xf bank_mask:0xf
    v_max3_f32 v4, v20, v21, v22
    v_max3_f32 v4, v4, v23, v24
    v_max3_f32 v4, v4, v25, v26
    v_max3_f32 v4, v4, v27, v28
    v_max3_f32 v4, v4, v29, v30
    v_max3_f32 v4, v4, v31, v32
    v_max3_f32 v4, v4, v33, v34
    v_max_f32 v4, v4, v35
    s_nop 0
    v_readlane_b32 s76, v4, 0
    v_readlane_b32 s77, v4, 16
    v_readlane_b32 s78, v4, 32
    v_readlane_b32 s79, v4, 48
    s_nop 1
    v_mov_b32 v4, s76
    v_max_f32 v4, s77, v4
    v_max_f32 v4, s78, v4
    v_max_f32 v4, s79, v4
    s_lshl_b32 s76, s11, 2
    v_mov_b32 v5, s76
    ds_write_b32 v5, v4 offset:4352
    s_waitcnt lgkmcnt(0)
    s_barrier
    v_mov_b32 v5, 0
    ds_read_b128 v[44:47], v5 offset:4352
    ds_read_b128 v[48:51], v5 offset:4368
    s_waitcnt lgkmcnt(0)
    v_max3_f32 v4, v44, v45, v46
    v_max3_f32 v4, v4, v47, v48
    v_max3_f32 v4, v4, v49, v50
    v_max_f32 v4, v4, v51
    v_mul_f32 v65, s82, v4
    v_fma_f32 v20, v20, s82, -v65
    v_fma_f32 v21, v21, s82, -v65
    v_fma_f32 v22, v22, s82, -v65
    v_fma_f32 v23, v23, s82, -v65
    v_fma_f32 v24, v24, s82, -v65
    v_fma_f32 v25, v25, s82, -v65
    v_fma_f32 v26, v26, s82, -v65
    v_fma_f32 v27, v27, s82, -v65
    v_fma_f32 v28, v28, s82, -v65
    v_fma_f32 v29, v29, s82, -v65
    v_fma_f32 v30, v30, s82, -v65
    v_fma_f32 v31, v31, s82, -v65
    v_fma_f32 v32, v32, s82, -v65
    v_fma_f32 v33, v33, s82, -v65
    v_fma_f32 v34, v34, s82, -v65
    v_fma_f32 v35, v35, s82, -v65
    v_exp_f32 v20, v20
    v_exp_f32 v21, v21
    v_exp_f32 v22, v22
    v_exp_f32 v23, v23
    v_exp_f32 v24, v24
    v_exp_f32 v25, v25
    v_exp_f32 v26, v26
    v_exp_f32 v27, v27
    v_exp_f32 v28, v28
    v_exp_f32 v29, v29
    v_exp_f32 v30, v30
    v_exp_f32 v31, v31
    v_exp_f32 v32, v32
    v_exp_f32 v33, v33
    v_exp_f32 v34, v34
    v_exp_f32 v35, v35
    s_nop 0
    v_add_f32 v64, v20, v21
    v_add_f32 v64, v64, v22
    v_add_f32 v64, v64, v23
    v_add_f32 v64, v64, v24
    v_add_f32 v64, v64, v25
    v_add_f32 v64, v64, v26
    v_add_f32 v64, v64, v27
    v_add_f32 v64, v64, v28
    v_add_f32 v64, v64, v29
    v_add_f32 v64, v64, v30
    v_add_f32 v64, v64, v31
    v_add_f32 v64, v64, v32
    v_add_f32 v64, v64, v33
    v_add_f32 v64, v64, v34
    v_add_f32 v64, v64, v35
    s_lshl_b32 s76, s11, 4
    v_lshlrev_b32 v4, 2, v3
    v_add_u32 v4, s76, v4
    s_mov_b64 exec, s[84:85]
    ds_write_b32 v4, v64 offset:4384
    s_mov_b64 exec, -1
    v_cvt_pk_bf16_f32 v20, v20, v21
    v_cvt_pk_bf16_f32 v22, v22, v23
    v_cvt_pk_bf16_f32 v24, v24, v25
    v_cvt_pk_bf16_f32 v26, v26, v27
    v_cvt_pk_bf16_f32 v28, v28, v29
    v_cvt_pk_bf16_f32 v30, v30, v31
    v_cvt_pk_bf16_f32 v32, v32, v33
    v_cvt_pk_bf16_f32 v34, v34, v35
    s_waitcnt lgkmcnt(0)
    s_barrier
    v_lshlrev_b32 v4, 2, v1
    v_and_b32 v4, 127, v4
    ds_read_b32 v5, v4 offset:4384
    s_waitcnt lgkmcnt(0)
    s_nop 1
    v_add_f32_dpp v5, v5, v5 quad_perm:[1,0,3,2] row_mask:0xf bank_mask:0xf
    s_nop 1
    v_add_f32_dpp v5, v5, v5 quad_perm:[2,3,0,1] row_mask:0xf bank_mask:0xf
    s_nop 1
    v_add_f32_dpp v5, v5, v5 row_half_mirror row_mask:0xf bank_mask:0xf
    s_nop 1
    v_add_f32_dpp v5, v5, v5 row_mirror row_mask:0xf bank_mask:0xf
    s_nop 1
    v_readlane_b32 s76, v5, 16
    s_nop 1
    v_add_f32 v5, s76, v5
    v_mov_b32 v72, v65
    v_mov_b32 v73, v5
    v_mov_b32 v74, s42
    v_mov_b32 v75, s43
    v_perm_b32 v44, v20, v20, v12
    v_perm_b32 v45, v20, v20, v13
    v_perm_b32 v46, v20, v20, v14
    v_perm_b32 v47, v20, v20, v15
    v_perm_b32 v48, v20, v20, v16
    v_perm_b32 v49, v20, v20, v17
    v_perm_b32 v50, v20, v20, v18
    v_perm_b32 v51, v20, v20, v19
    s_waitcnt vmcnt(15)
    v_mfma_f32_16x16x32_bf16 v[52:55], v[160:163], v[44:47], 0
    v_perm_b32 v44, v22, v22, v12
    v_perm_b32 v45, v22, v22, v13
    v_perm_b32 v46, v22, v22, v14
    v_perm_b32 v47, v22, v22, v15
    s_waitcnt vmcnt(14)
    v_mfma_f32_16x16x32_bf16 v[52:55], v[164:167], v[48:51], v[52:55]
    v_perm_b32 v48, v22, v22, v16
    v_perm_b32 v49, v22, v22, v17
    v_perm_b32 v50, v22, v22, v18
    v_perm_b32 v51, v22, v22, v19
    s_waitcnt vmcnt(13)
    v_mfma_f32_16x16x32_bf16 v[52:55], v[168:171], v[44:47], v[52:55]
    v_perm_b32 v44, v24, v24, v12
    v_perm_b32 v45, v24, v24, v13
    v_perm_b32 v46, v24, v24, v14
    v_perm_b32 v47, v24, v24, v15
    s_waitcnt vmcnt(12)
    v_mfma_f32_16x16x32_bf16 v[52:55], v[172:175], v[48:51], v[52:55]
    v_perm_b32 v48, v24, v24, v16
    v_perm_b32 v49, v24, v24, v17
    v_perm_b32 v50, v24, v24, v18
    v_perm_b32 v51, v24, v24, v19
    s_waitcnt vmcnt(11)
    v_mfma_f32_16x16x32_bf16 v[52:55], v[176:179], v[44:47], v[52:55]
    v_perm_b32 v44, v26, v26, v12
    v_perm_b32 v45, v26, v26, v13
    v_perm_b32 v46, v26, v26, v14
    v_perm_b32 v47, v26, v26, v15
    s_waitcnt vmcnt(10)
    v_mfma_f32_16x16x32_bf16 v[52:55], v[180:183], v[48:51], v[52:55]
    v_perm_b32 v48, v26, v26, v16
    v_perm_b32 v49, v26, v26, v17
    v_perm_b32 v50, v26, v26, v18
    v_perm_b32 v51, v26, v26, v19
    s_waitcnt vmcnt(9)
    v_mfma_f32_16x16x32_bf16 v[52:55], v[184:187], v[44:47], v[52:55]
    v_perm_b32 v44, v28, v28, v12
    v_perm_b32 v45, v28, v28, v13
    v_perm_b32 v46, v28, v28, v14
    v_perm_b32 v47, v28, v28, v15
    s_waitcnt vmcnt(8)
    v_mfma_f32_16x16x32_bf16 v[52:55], v[188:191], v[48:51], v[52:55]
    v_perm_b32 v48, v28, v28, v16
    v_perm_b32 v49, v28, v28, v17
    v_perm_b32 v50, v28, v28, v18
    v_perm_b32 v51, v28, v28, v19
    s_waitcnt vmcnt(7)
    v_mfma_f32_16x16x32_bf16 v[52:55], v[192:195], v[44:47], v[52:55]
    v_perm_b32 v44, v30, v30, v12
    v_perm_b32 v45, v30, v30, v13
    v_perm_b32 v46, v30, v30, v14
    v_perm_b32 v47, v30, v30, v15
    s_waitcnt vmcnt(6)
    v_mfma_f32_16x16x32_bf16 v[52:55], v[196:199], v[48:51], v[52:55]
    v_perm_b32 v48, v30, v30, v16
    v_perm_b32 v49, v30, v30, v17
    v_perm_b32 v50, v30, v30, v18
    v_perm_b32 v51, v30, v30, v19
    s_waitcnt vmcnt(5)
    v_mfma_f32_16x16x32_bf16 v[52:55], v[200:203], v[44:47], v[52:55]
    v_perm_b32 v44, v32, v32, v12
    v_perm_b32 v45, v32, v32, v13
    v_perm_b32 v46, v32, v32, v14
    v_perm_b32 v47, v32, v32, v15
    s_waitcnt vmcnt(4)
    v_mfma_f32_16x16x32_bf16 v[52:55], v[204:207], v[48:51], v[52:55]
    v_perm_b32 v48, v32, v32, v16
    v_perm_b32 v49, v32, v32, v17
    v_perm_b32 v50, v32, v32, v18
    v_perm_b32 v51, v32, v32, v19
    s_waitcnt vmcnt(3)
    v_mfma_f32_16x16x32_bf16 v[52:55], v[208:211], v[44:47], v[52:55]
    v_perm_b32 v44, v34, v34, v12
    v_perm_b32 v45, v34, v34, v13
    v_perm_b32 v46, v34, v34, v14
    v_perm_b32 v47, v34, v34, v15
    s_waitcnt vmcnt(2)
    v_mfma_f32_16x16x32_bf16 v[52:55], v[212:215], v[48:51], v[52:55]
    v_perm_b32 v48, v34, v34, v16
    v_perm_b32 v49, v34, v34, v17
    v_perm_b32 v50, v34, v34, v18
    v_perm_b32 v51, v34, v34, v19
    s_waitcnt vmcnt(1)
    v_mfma_f32_16x16x32_bf16 v[52:55], v[216:219], v[44:47], v[52:55]
    s_nop 1
    s_waitcnt vmcnt(0)
    v_mfma_f32_16x16x32_bf16 v[52:55], v[220:223], v[48:51], v[52:55]
    s_branch L_tail
L5_start:
    s_add_u32 s76, s83, 8192
    buffer_load_dwordx4 v[192:195], v61, s[56:59], s76 offen offset:0 nt
    buffer_load_dwordx4 v[196:199], v61, s[56:59], s76 offen offset:1024 nt
    buffer_load_dwordx4 v[200:203], v61, s[56:59], s76 offen offset:2048 nt
    buffer_load_dwordx4 v[204:207], v61, s[56:59], s76 offen offset:3072 nt
    s_add_u32 s76, s76, 4096
    buffer_load_dwordx4 v[208:211], v61, s[56:59], s76 offen offset:0 nt
    buffer_load_dwordx4 v[212:215], v61, s[56:59], s76 offen offset:1024 nt
    buffer_load_dwordx4 v[216:219], v61, s[56:59], s76 offen offset:2048 nt
    buffer_load_dwordx4 v[220:223], v61, s[56:59], s76 offen offset:3072 nt
    s_add_u32 s76, s76, 4096
    buffer_load_dwordx4 v[224:227], v61, s[56:59], s76 offen offset:0 nt
    buffer_load_dwordx4 v[228:231], v61, s[56:59], s76 offen offset:1024 nt
    buffer_load_dwordx4 v[232:235], v61, s[56:59], s76 offen offset:2048 nt
    buffer_load_dwordx4 v[236:239], v61, s[56:59], s76 offen offset:3072 nt
    s_cmp_eq_u32 s11, 0
    s_cbranch_scc1 L5_poll
    s_add_u32 s76, s15, 0
    s_and_b32 s76, s76, 3
    s_mul_i32 s76, s76, 40960
    buffer_load_dwordx4 v[80:83], v63, s[64:67], s76 offen offset:0
    buffer_load_dwordx4 v[84:87], v63, s[64:67], s76 offen offset:256
    buffer_load_dwordx4 v[88:91], v63, s[64:67], s76 offen offset:512
    buffer_load_dwordx4 v[92:95], v63, s[64:67], s76 offen offset:768
    buffer_load_dwordx4 v[96:99], v63, s[64:67], s76 offen offset:1024
    s_add_u32 s76, s15, 1
    s_and_b32 s76, s76, 3
    s_mul_i32 s76, s76, 40960
    buffer_load_dwordx4 v[100:103], v63, s[64:67], s76 offen offset:0
    buffer_load_dwordx4 v[104:107], v63, s[64:67], s76 offen offset:256
    buffer_load_dwordx4 v[108:111], v63, s[64:67], s76 offen offset:512
    buffer_load_dwordx4 v[112:115], v63, s[64:67], s76 offen offset:768
    buffer_load_dwordx4 v[116:119], v63, s[64:67], s76 offen offset:1024
    s_add_u32 s76, s15, 2
    s_and_b32 s76, s76, 3
    s_mul_i32 s76, s76, 40960
    buffer_load_dwordx4 v[120:123], v63, s[64:67], s76 offen offset:0
    buffer_load_dwordx4 v[124:127], v63, s[64:67], s76 offen offset:256
    buffer_load_dwordx4 v[128:131], v63, s[64:67], s76 offen offset:512
    buffer_load_dwordx4 v[132:135], v63, s[64:67], s76 offen offset:768
    buffer_load_dwordx4 v[136:139], v63, s[64:67], s76 offen offset:1024
    s_add_u32 s76, s15, 3
    s_and_b32 s76, s76, 3
    s_mul_i32 s76, s76, 40960
    buffer_load_dwordx4 v[140:143], v63, s[64:67], s76 offen offset:0
    buffer_load_dwordx4 v[144:147], v63, s[64:67], s76 offen offset:256
    buffer_load_dwordx4 v[148:151], v63, s[64:67], s76 offen offset:512
    buffer_load_dwordx4 v[152:155], v63, s[64:67], s76 offen offset:768
    buffer_load_dwordx4 v[156:159], v63, s[64:67], s76 offen offset:1024
    s_branch L5_bar2
L5_poll:
    v_lshlrev_b32 v8, 4, v1
    s_mov_b64 exec, 0xffffffff
L5_fok:
    buffer_load_dwordx4 v[20:23], v8, s[88:91], 0 offen offset:0 sc1
    buffer_load_dwordx4 v[24:27], v8, s[88:91], 0 offen offset:512 sc1
    s_cmp_eq_u32 s12, 0
    s_cbranch_scc1 L5_pA
    buffer_load_dwordx4 v[28:31], v8, s[88:91], 0 offen offset:1024 sc1
    buffer_load_dwordx4 v[32:35], v8, s[88:91], 0 offen offset:1536 sc1
    buffer_load_dwordx4 v[36:39], v8, s[88:91], 0 offen offset:2048 sc1
    buffer_load_dwordx4 v[40:43], v8, s[88:91], 0 offen offset:2560 sc1
    s_waitcnt vmcnt(0)
    v_xor_b32 v44, s94, v20
    v_xor_b32 v45, s95, v21
    v_xor_b32 v46, s96, v22
    v_xor_b32 v47, s98, v23
    v_or3_b32 v7, v44, v45, v46
    v_or_b32 v7, v7, v47
    v_xor_b32 v44, s94, v24
    v_xor_b32 v45, s95, v25
    v_xor_b32 v46, s96, v26
    v_xor_b32 v47, s98, v27
    v_or3_b32 v7, v7, v44, v45
    v_or3_b32 v7, v7, v46, v47
    v_xor_b32 v44, s94, v28
    v_xor_b32 v45, s95, v29
    v_xor_b32 v46, s96, v30
    v_xor_b32 v47, s98, v31
    v_or3_b32 v7, v7, v44, v45
    v_or3_b32 v7, v7, v46, v47
    v_xor_b32 v44, s94, v32
    v_xor_b32 v45, s95, v33
    v_xor_b32 v46, s96, v34
    v_xor_b32 v47, s98, v35
    v_or3_b32 v7, v7, v44, v45
    v_or3_b32 v7, v7, v46, v47
    v_xor_b32 v44, s94, v36
    v_xor_b32 v45, s95, v37
    v_xor_b32 v46, s96, v38
    v_xor_b32 v47, s98, v39
    v_or3_b32 v7, v7, v44, v45
    v_or3_b32 v7, v7, v46, v47
    v_xor_b32 v44, s94, v40
    v_xor_b32 v45, s95, v41
    v_xor_b32 v46, s96, v42
    v_xor_b32 v47, s98, v43
    v_or3_b32 v7, v7, v44, v45
    v_or3_b32 v7, v7, v46, v47
    v_and_b32 v7, 0xfff, v7
    v_cmp_ne_u32 vcc, 0, v7
    s_cbranch_vccz L5_qokB
    s_sleep 2
    s_branch L5_fok
L5_qokB:
    v_add_f32 v20, v20, v24
    v_add_f32 v28, v28, v32
    v_add_f32 v36, v36, v40
    v_add_f32 v21, v21, v25
    v_add_f32 v29, v29, v33
    v_add_f32 v37, v37, v41
    v_add_f32 v22, v22, v26
    v_add_f32 v30, v30, v34
    v_add_f32 v38, v38, v42
    v_add_f32 v23, v23, v27
    v_add_f32 v31, v31, v35
    v_add_f32 v39, v39, v43
    v_add_f32 v20, v20, v28
    v_add_f32 v21, v21, v29
    v_add_f32 v22, v22, v30
    v_add_f32 v23, v23, v31
    v_add_f32 v20, v20, v36
    v_add_f32 v21, v21, v37
    v_add_f32 v22, v22, v38
    v_add_f32 v23, v23, v39
    s_branch L5_qsum
L5_pA:
    s_waitcnt vmcnt(0)
    v_xor_b32 v44, s94, v20
    v_xor_b32 v45, s95, v21
    v_xor_b32 v46, s96, v22
    v_xor_b32 v47, s98, v23
    v_or3_b32 v7, v44, v45, v46
    v_or_b32 v7, v7, v47
    v_xor_b32 v44, s94, v24
    v_xor_b32 v45, s95, v25
    v_xor_b32 v46, s96, v26
    v_xor_b32 v47, s98, v27
    v_or3_b32 v7, v7, v44, v45
    v_or3_b32 v7, v7, v46, v47
    v_and_b32 v7, 0xfff, v7
    v_cmp_ne_u32 vcc, 0, v7
    s_cbranch_vccz L5_qokA
    s_sleep 2
    s_branch L5_fok
L5_qokA:
    v_add_f32 v20, v20, v24
    v_add_f32 v21, v21, v25
    v_add_f32 v22, v22, v26
    v_add_f32 v23, v23, v27
L5_qsum:
    v_cvt_pk_bf16_f32 v20, v20, v21
    v_cvt_pk_bf16_f32 v22, v22, v23
    v_lshrrev_b32 v6, 3, v1
    v_lshlrev_b32 v6, 6, v6
    v_and_b32 v7, 7, v1
    v_lshl_add_u32 v6, v7, 1, v6
    ds_write_b16 v6, v20 offset:4096
    ds_write_b16_d16_hi v6, v20 offset:4112
    ds_write_b16 v6, v22 offset:4128
    ds_write_b16_d16_hi v6, v22 offset:4144
    s_mov_b64 exec, -1
    s_waitcnt lgkmcnt(0)
L5_bar2:
    s_barrier
    v_and_b32 v4, 3, v2
    v_lshl_add_u32 v4, v3, 2, v4
    v_lshlrev_b32 v4, 4, v4
    ds_read_b128 v[44:47], v4 offset:4096
    s_cmp_lg_u32 s11, 0
    s_cbranch_scc1 L5_wodone
    s_add_u32 s76, s15, 0
    s_and_b32 s76, s76, 3
    s_mul_i32 s76, s76, 40960
    buffer_load_dwordx4 v[80:83], v63, s[64:67], s76 offen offset:0
    buffer_load_dwordx4 v[84:87], v63, s[64:67], s76 offen offset:256
    buffer_load_dwordx4 v[88:91], v63, s[64:67], s76 offen offset:512
    buffer_load_dwordx4 v[92:95], v63, s[64:67], s76 offen offset:768
    buffer_load_dwordx4 v[96:99], v63, s[64:67], s76 offen offset:1024
    s_add_u32 s76, s15, 1
    s_and_b32 s76, s76, 3
    s_mul_i32 s76, s76, 40960
    buffer_load_dwordx4 v[100:103], v63, s[64:67], s76 offen offset:0
    buffer_load_dwordx4 v[104:107], v63, s[64:67], s76 offen offset:256
    buffer_load_dwordx4 v[108:111], v63, s[64:67], s76 offen offset:512
    buffer_load_dwordx4 v[112:115], v63, s[64:67], s76 offen offset:768
    buffer_load_dwordx4 v[116:119], v63, s[64:67], s76 offen offset:1024
    s_add_u32 s76, s15, 2
    s_and_b32 s76, s76, 3
    s_mul_i32 s76, s76, 40960
    buffer_load_dwordx4 v[120:123], v63, s[64:67], s76 offen offset:0
    buffer_load_dwordx4 v[124:127], v63, s[64:67], s76 offen offset:256
    buffer_load_dwordx4 v[128:131], v63, s[64:67], s76 offen offset:512
    buffer_load_dwordx4 v[132:135], v63, s[64:67], s76 offen offset:768
    buffer_load_dwordx4 v[136:139], v63, s[64:67], s76 offen offset:1024
    s_add_u32 s76, s15, 3
    s_and_b32 s76, s76, 3
    s_mul_i32 s76, s76, 40960
    buffer_load_dwordx4 v[140:143], v63, s[64:67], s76 offen offset:0
    buffer_load_dwordx4 v[144:147], v63, s[64:67], s76 offen offset:256
    buffer_load_dwordx4 v[148:151], v63, s[64:67], s76 offen offset:512
    buffer_load_dwordx4 v[152:155], v63, s[64:67], s76 offen offset:768
    buffer_load_dwordx4 v[156:159], v63, s[64:67], s76 offen offset:1024
L5_wodone:
    s_waitcnt lgkmcnt(0)
    s_mov_b32 s76, s83
    s_waitcnt vmcnt(36)
    v_mfma_f32_16x16x32_bf16 v[48:51], v[160:163], v[44:47], 0
    v_mfma_f32_16x16x32_bf16 v[52:55], v[164:167], v[44:47], 0
    v_mfma_f32_16x16x32_bf16 v[56:59], v[168:171], v[44:47], 0
    v_mfma_f32_16x16x32_bf16 v[76:79], v[172:175], v[44:47], 0
    buffer_load_dwordx4 v[160:163], v62, s[60:63], s76 offen offset:0 nt
    buffer_load_dwordx4 v[164:167], v62, s[60:63], s76 offen offset:1024 nt
    buffer_load_dwordx4 v[168:171], v62, s[60:63], s76 offen offset:2048 nt
    buffer_load_dwordx4 v[172:175], v62, s[60:63], s76 offen offset:3072 nt
    s_nop 1
    v_mov_b32_dpp v20, v48 quad_perm:[0,0,0,0] row_mask:0xf bank_mask:0xf
    v_mov_b32_dpp v21, v52 quad_perm:[0,0,0,0] row_mask:0xf bank_mask:0xf
    v_mov_b32_dpp v22, v56 quad_perm:[0,0,0,0] row_mask:0xf bank_mask:0xf
    v_mov_b32_dpp v23, v76 quad_perm:[0,0,0,0] row_mask:0xf bank_mask:0xf
    v_add_f32_dpp v20, v49, v20 quad_perm:[1,1,1,1] row_mask:0xf bank_mask:0xf
    v_add_f32_dpp v21, v53, v21 quad_perm:[1,1,1,1] row_mask:0xf bank_mask:0xf
    v_add_f32_dpp v22, v57, v22 quad_perm:[1,1,1,1] row_mask:0xf bank_mask:0xf
    v_add_f32_dpp v23, v77, v23 quad_perm:[1,1,1,1] row_mask:0xf bank_mask:0xf
    v_add_f32_dpp v20, v50, v20 quad_perm:[2,2,2,2] row_mask:0xf bank_mask:0xf
    v_add_f32_dpp v21, v54, v21 quad_perm:[2,2,2,2] row_mask:0xf bank_mask:0xf
    v_add_f32_dpp v22, v58, v22 quad_perm:[2,2,2,2] row_mask:0xf bank_mask:0xf
    v_add_f32_dpp v23, v78, v23 quad_perm:[2,2,2,2] row_mask:0xf bank_mask:0xf
    v_add_f32_dpp v20, v51, v20 quad_perm:[3,3,3,3] row_mask:0xf bank_mask:0xf
    v_add_f32_dpp v21, v55, v21 quad_perm:[3,3,3,3] row_mask:0xf bank_mask:0xf
    v_add_f32_dpp v22, v59, v22 quad_perm:[3,3,3,3] row_mask:0xf bank_mask:0xf
    v_add_f32_dpp v23, v79, v23 quad_perm:[3,3,3,3] row_mask:0xf bank_mask:0xf
    s_add_u32 s76, s76, 4096
    s_waitcnt vmcnt(36)
    v_mfma_f32_16x16x32_bf16 v[48:51], v[176:179], v[44:47], 0
    v_mfma_f32_16x16x32_bf16 v[52:55], v[180:183], v[44:47], 0
    v_mfma_f32_16x16x32_bf16 v[56:59], v[184:187], v[44:47], 0
    v_mfma_f32_16x16x32_bf16 v[76:79], v[188:191], v[44:47], 0
    buffer_load_dwordx4 v[176:179], v62, s[60:63], s76 offen offset:0 nt
    buffer_load_dwordx4 v[180:183], v62, s[60:63], s76 offen offset:1024 nt
    buffer_load_dwordx4 v[184:187], v62, s[60:63], s76 offen offset:2048 nt
    buffer_load_dwordx4 v[188:191], v62, s[60:63], s76 offen offset:3072 nt
    s_nop 1
    v_mov_b32_dpp v24, v48 quad_perm:[0,0,0,0] row_mask:0xf bank_mask:0xf
    v_mov_b32_dpp v25, v52 quad_perm:[0,0,0,0] row_mask:0xf bank_mask:0xf
    v_mov_b32_dpp v26, v56 quad_perm:[0,0,0,0] row_mask:0xf bank_mask:0xf
    v_mov_b32_dpp v27, v76 quad_perm:[0,0,0,0] row_mask:0xf bank_mask:0xf
    v_add_f32_dpp v24, v49, v24 quad_perm:[1,1,1,1] row_mask:0xf bank_mask:0xf
    v_add_f32_dpp v25, v53, v25 quad_perm:[1,1,1,1] row_mask:0xf bank_mask:0xf
    v_add_f32_dpp v26, v57, v26 quad_perm:[1,1,1,1] row_mask:0xf bank_mask:0xf
    v_add_f32_dpp v27, v77, v27 quad_perm:[1,1,1,1] row_mask:0xf bank_mask:0xf
    v_add_f32_dpp v24, v50, v24 quad_perm:[2,2,2,2] row_mask:0xf bank_mask:0xf
    v_add_f32_dpp v25, v54, v25 quad_perm:[2,2,2,2] row_mask:0xf bank_mask:0xf
    v_add_f32_dpp v26, v58, v26 quad_perm:[2,2,2,2] row_mask:0xf bank_mask:0xf
    v_add_f32_dpp v27, v78, v27 quad_perm:[2,2,2,2] row_mask:0xf bank_mask:0xf
    v_add_f32_dpp v24, v51, v24 quad_perm:[3,3,3,3] row_mask:0xf bank_mask:0xf
    v_add_f32_dpp v25, v55, v25 quad_perm:[3,3,3,3] row_mask:0xf bank_mask:0xf
    v_add_f32_dpp v26, v59, v26 quad_perm:[3,3,3,3] row_mask:0xf bank_mask:0xf
    v_add_f32_dpp v27, v79, v27 quad_perm:[3,3,3,3] row_mask:0xf bank_mask:0xf
    s_add_u32 s76, s76, 4096
    s_waitcnt vmcnt(36)
    v_mfma_f32_16x16x32_bf16 v[48:51], v[192:195], v[44:47], 0
    v_mfma_f32_16x16x32_bf16 v[52:55], v[196:199], v[44:47], 0
    v_mfma_f32_16x16x32_bf16 v[56:59], v[200:203], v[44:47], 0
    v_mfma_f32_16x16x32_bf16 v[76:79], v[204:207], v[44:47], 0
    buffer_load_dwordx4 v[192:195], v62, s[60:63], s76 offen offset:0 nt
    buffer_load_dwordx4 v[196:199], v62, s[60:63], s76 offen offset:1024 nt
    buffer_load_dwordx4 v[200:203], v62, s[60:63], s76 offen offset:2048 nt
    buffer_load_dwordx4 v[204:207], v62, s[60:63], s76 offen offset:3072 nt
    s_nop 1
    v_mov_b32_dpp v28, v48 quad_perm:[0,0,0,0] row_mask:0xf bank_mask:0xf
    v_mov_b32_dpp v29, v52 quad_perm:[0,0,0,0] row_mask:0xf bank_mask:0xf
    v_mov_b32_dpp v30, v56 quad_perm:[0,0,0,0] row_mask:0xf bank_mask:0xf
    v_mov_b32_dpp v31, v76 quad_perm:[0,0,0,0] row_mask:0xf bank_mask:0xf
    v_add_f32_dpp v28, v49, v28 quad_perm:[1,1,1,1] row_mask:0xf bank_mask:0xf
    v_add_f32_dpp v29, v53, v29 quad_perm:[1,1,1,1] row_mask:0xf bank_mask:0xf
    v_add_f32_dpp v30, v57, v30 quad_perm:[1,1,1,1] row_mask:0xf bank_mask:0xf
    v_add_f32_dpp v31, v77, v31 quad_perm:[1,1,1,1] row_mask:0xf bank_mask:0xf
    v_add_f32_dpp v28, v50, v28 quad_perm:[2,2,2,2] row_mask:0xf bank_mask:0xf
    v_add_f32_dpp v29, v54, v29 quad_perm:[2,2,2,2] row_mask:0xf bank_mask:0xf
    v_add_f32_dpp v30, v58, v30 quad_perm:[2,2,2,2] row_mask:0xf bank_mask:0xf
    v_add_f32_dpp v31, v78, v31 quad_perm:[2,2,2,2] row_mask:0xf bank_mask:0xf
    v_add_f32_dpp v28, v51, v28 quad_perm:[3,3,3,3] row_mask:0xf bank_mask:0xf
    v_add_f32_dpp v29, v55, v29 quad_perm:[3,3,3,3] row_mask:0xf bank_mask:0xf
    v_add_f32_dpp v30, v59, v30 quad_perm:[3,3,3,3] row_mask:0xf bank_mask:0xf
    v_add_f32_dpp v31, v79, v31 quad_perm:[3,3,3,3] row_mask:0xf bank_mask:0xf
    s_add_u32 s76, s76, 4096
    s_waitcnt vmcnt(36)
    v_mfma_f32_16x16x32_bf16 v[48:51], v[208:211], v[44:47], 0
    v_mfma_f32_16x16x32_bf16 v[52:55], v[212:215], v[44:47], 0
    v_mfma_f32_16x16x32_bf16 v[56:59], v[216:219], v[44:47], 0
    v_mfma_f32_16x16x32_bf16 v[76:79], v[220:223], v[44:47], 0
    buffer_load_dwordx4 v[208:211], v62, s[60:63], s76 offen offset:0 nt
    buffer_load_dwordx4 v[212:215], v62, s[60:63], s76 offen offset:1024 nt
    buffer_load_dwordx4 v[216:219], v62, s[60:63], s76 offen offset:2048 nt
    buffer_load_dwordx4 v[220:223], v62, s[60:63], s76 offen offset:3072 nt
    s_nop 1
    v_mov_b32_dpp v32, v48 quad_perm:[0,0,0,0] row_mask:0xf bank_mask:0xf
    v_mov_b32_dpp v33, v52 quad_perm:[0,0,0,0] row_mask:0xf bank_mask:0xf
    v_mov_b32_dpp v34, v56 quad_perm:[0,0,0,0] row_mask:0xf bank_mask:0xf
    v_mov_b32_dpp v35, v76 quad_perm:[0,0,0,0] row_mask:0xf bank_mask:0xf
    v_add_f32_dpp v32, v49, v32 quad_perm:[1,1,1,1] row_mask:0xf bank_mask:0xf
    v_add_f32_dpp v33, v53, v33 quad_perm:[1,1,1,1] row_mask:0xf bank_mask:0xf
    v_add_f32_dpp v34, v57, v34 quad_perm:[1,1,1,1] row_mask:0xf bank_mask:0xf
    v_add_f32_dpp v35, v77, v35 quad_perm:[1,1,1,1] row_mask:0xf bank_mask:0xf
    v_add_f32_dpp v32, v50, v32 quad_perm:[2,2,2,2] row_mask:0xf bank_mask:0xf
    v_add_f32_dpp v33, v54, v33 quad_perm:[2,2,2,2] row_mask:0xf bank_mask:0xf
    v_add_f32_dpp v34, v58, v34 quad_perm:[2,2,2,2] row_mask:0xf bank_mask:0xf
    v_add_f32_dpp v35, v78, v35 quad_perm:[2,2,2,2] row_mask:0xf bank_mask:0xf
    v_add_f32_dpp v32, v51, v32 quad_perm:[3,3,3,3] row_mask:0xf bank_mask:0xf
    v_add_f32_dpp v33, v55, v33 quad_perm:[3,3,3,3] row_mask:0xf bank_mask:0xf
    v_add_f32_dpp v34, v59, v34 quad_perm:[3,3,3,3] row_mask:0xf bank_mask:0xf
    v_add_f32_dpp v35, v79, v35 quad_perm:[3,3,3,3] row_mask:0xf bank_mask:0xf
    s_add_u32 s76, s76, 4096
    s_waitcnt vmcnt(36)
    v_mfma_f32_16x16x32_bf16 v[48:51], v[224:227], v[44:47], 0
    v_mfma_f32_16x16x32_bf16 v[52:55], v[228:231], v[44:47], 0
    v_mfma_f32_16x16x32_bf16 v[56:59], v[232:235], v[44:47], 0
    v_mfma_f32_16x16x32_bf16 v[76:79], v[236:239], v[44:47], 0
    buffer_load_dwordx4 v[224:227], v62, s[60:63], s76 offen offset:0 nt
    buffer_load_dwordx4 v[228:231], v62, s[60:63], s76 offen offset:1024 nt
    buffer_load_dwordx4 v[232:235], v62, s[60:63], s76 offen offset:2048 nt
    buffer_load_dwordx4 v[236:239], v62, s[60:63], s76 offen offset:3072 nt
    s_nop 1
    v_mov_b32_dpp v36, v48 quad_perm:[0,0,0,0] row_mask:0xf bank_mask:0xf
    v_mov_b32_dpp v37, v52 quad_perm:[0,0,0,0] row_mask:0xf bank_mask:0xf
    v_mov_b32_dpp v38, v56 quad_perm:[0,0,0,0] row_mask:0xf bank_mask:0xf
    v_mov_b32_dpp v39, v76 quad_perm:[0,0,0,0] row_mask:0xf bank_mask:0xf
    v_add_f32_dpp v36, v49, v36 quad_perm:[1,1,1,1] row_mask:0xf bank_mask:0xf
    v_add_f32_dpp v37, v53, v37 quad_perm:[1,1,1,1] row_mask:0xf bank_mask:0xf
    v_add_f32_dpp v38, v57, v38 quad_perm:[1,1,1,1] row_mask:0xf bank_mask:0xf
    v_add_f32_dpp v39, v77, v39 quad_perm:[1,1,1,1] row_mask:0xf bank_mask:0xf
    v_add_f32_dpp v36, v50, v36 quad_perm:[2,2,2,2] row_mask:0xf bank_mask:0xf
    v_add_f32_dpp v37, v54, v37 quad_perm:[2,2,2,2] row_mask:0xf bank_mask:0xf
    v_add_f32_dpp v38, v58, v38 quad_perm:[2,2,2,2] row_mask:0xf bank_mask:0xf
    v_add_f32_dpp v39, v78, v39 quad_perm:[2,2,2,2] row_mask:0xf bank_mask:0xf
    v_add_f32_dpp v36, v51, v36 quad_perm:[3,3,3,3] row_mask:0xf bank_mask:0xf
    v_add_f32_dpp v37, v55, v37 quad_perm:[3,3,3,3] row_mask:0xf bank_mask:0xf
    v_add_f32_dpp v38, v59, v38 quad_perm:[3,3,3,3] row_mask:0xf bank_mask:0xf
    v_add_f32_dpp v39, v79, v39 quad_perm:[3,3,3,3] row_mask:0xf bank_mask:0xf
    v_max3_f32 v4, v20, v21, v22
    v_max3_f32 v4, v4, v23, v24
    v_max3_f32 v4, v4, v25, v26
    v_max3_f32 v4, v4, v27, v28
    v_max3_f32 v4, v4, v29, v30
    v_max3_f32 v4, v4, v31, v32
    v_max3_f32 v4, v4, v33, v34
    v_max3_f32 v4, v4, v35, v36
    v_max3_f32 v4, v4, v37, v38
    v_max_f32 v4, v4, v39
    s_nop 0
    v_readlane_b32 s76, v4, 0
    v_readlane_b32 s77, v4, 16
    v_readlane_b32 s78, v4, 32
    v_readlane_b32 s79, v4, 48
    s_nop 1
    v_mov_b32 v4, s76
    v_max_f32 v4, s77, v4
    v_max_f32 v4, s78, v4
    v_max_f32 v4, s79, v4
    s_lshl_b32 s76, s11, 2
    v_mov_b32 v5, s76
    ds_write_b32 v5, v4 offset:4352
    s_waitcnt lgkmcnt(0)
    s_barrier
    v_mov_b32 v5, 0
    ds_read_b128 v[44:47], v5 offset:4352
    ds_read_b128 v[48:51], v5 offset:4368
    s_waitcnt lgkmcnt(0)
    v_max3_f32 v4, v44, v45, v46
    v_max3_f32 v4, v4, v47, v48
    v_max3_f32 v4, v4, v49, v50
    v_max_f32 v4, v4, v51
    v_mul_f32 v65, s82, v4
    v_fma_f32 v20, v20, s82, -v65
    v_fma_f32 v21, v21, s82, -v65
    v_fma_f32 v22, v22, s82, -v65
    v_fma_f32 v23, v23, s82, -v65
    v_fma_f32 v24, v24, s82, -v65
    v_fma_f32 v25, v25, s82, -v65
    v_fma_f32 v26, v26, s82, -v65
    v_fma_f32 v27, v27, s82, -v65
    v_fma_f32 v28, v28, s82, -v65
    v_fma_f32 v29, v29, s82, -v65
    v_fma_f32 v30, v30, s82, -v65
    v_fma_f32 v31, v31, s82, -v65
    v_fma_f32 v32, v32, s82, -v65
    v_fma_f32 v33, v33, s82, -v65
    v_fma_f32 v34, v34, s82, -v65
    v_fma_f32 v35, v35, s82, -v65
    v_fma_f32 v36, v36, s82, -v65
    v_fma_f32 v37, v37, s82, -v65
    v_fma_f32 v38, v38, s82, -v65
    v_fma_f32 v39, v39, s82, -v65
    v_exp_f32 v20, v20
    v_exp_f32 v21, v21
    v_exp_f32 v22, v22
    v_exp_f32 v23, v23
    v_exp_f32 v24, v24
    v_exp_f32 v25, v25
    v_exp_f32 v26, v26
    v_exp_f32 v27, v27
    v_exp_f32 v28, v28
    v_exp_f32 v29, v29
    v_exp_f32 v30, v30
    v_exp_f32 v31, v31
    v_exp_f32 v32, v32
    v_exp_f32 v33, v33
    v_exp_f32 v34, v34
    v_exp_f32 v35, v35
    v_exp_f32 v36, v36
    v_exp_f32 v37, v37
    v_exp_f32 v38, v38
    v_exp_f32 v39, v39
    s_nop 0
    v_add_f32 v64, v20, v21
    v_add_f32 v64, v64, v22
    v_add_f32 v64, v64, v23
    v_add_f32 v64, v64, v24
    v_add_f32 v64, v64, v25
    v_add_f32 v64, v64, v26
    v_add_f32 v64, v64, v27
    v_add_f32 v64, v64, v28
    v_add_f32 v64, v64, v29
    v_add_f32 v64, v64, v30
    v_add_f32 v64, v64, v31
    v_add_f32 v64, v64, v32
    v_add_f32 v64, v64, v33
    v_add_f32 v64, v64, v34
    v_add_f32 v64, v64, v35
    v_add_f32 v64, v64, v36
    v_add_f32 v64, v64, v37
    v_add_f32 v64, v64, v38
    v_add_f32 v64, v64, v39
    s_lshl_b32 s76, s11, 4
    v_lshlrev_b32 v4, 2, v3
    v_add_u32 v4, s76, v4
    s_mov_b64 exec, s[84:85]
    ds_write_b32 v4, v64 offset:4384
    s_mov_b64 exec, -1
    v_cvt_pk_bf16_f32 v20, v20, v21
    v_cvt_pk_bf16_f32 v22, v22, v23
    v_cvt_pk_bf16_f32 v24, v24, v25
    v_cvt_pk_bf16_f32 v26, v26, v27
    v_cvt_pk_bf16_f32 v28, v28, v29
    v_cvt_pk_bf16_f32 v30, v30, v31
    v_cvt_pk_bf16_f32 v32, v32, v33
    v_cvt_pk_bf16_f32 v34, v34, v35
    v_cvt_pk_bf16_f32 v36, v36, v37
    v_cvt_pk_bf16_f32 v38, v38, v39
    s_waitcnt lgkmcnt(0)
    s_barrier
    v_lshlrev_b32 v4, 2, v1
    v_and_b32 v4, 127, v4
    ds_read_b32 v5, v4 offset:4384
    s_waitcnt lgkmcnt(0)
    s_nop 1
    v_add_f32_dpp v5, v5, v5 quad_perm:[1,0,3,2] row_mask:0xf bank_mask:0xf
    s_nop 1
    v_add_f32_dpp v5, v5, v5 quad_perm:[2,3,0,1] row_mask:0xf bank_mask:0xf
    s_nop 1
    v_add_f32_dpp v5, v5, v5 row_half_mirror row_mask:0xf bank_mask:0xf
    s_nop 1
    v_add_f32_dpp v5, v5, v5 row_mirror row_mask:0xf bank_mask:0xf
    s_nop 1
    v_readlane_b32 s76, v5, 16
    s_nop 1
    v_add_f32 v5, s76, v5
    v_mov_b32 v72, v65
    v_mov_b32 v73, v5
    v_mov_b32 v74, s42
    v_mov_b32 v75, s43
    v_perm_b32 v44, v20, v20, v12
    v_perm_b32 v45, v20, v20, v13
    v_perm_b32 v46, v20, v20, v14
    v_perm_b32 v47, v20, v20, v15
    v_perm_b32 v48, v20, v20, v16
    v_perm_b32 v49, v20, v20, v17
    v_perm_b32 v50, v20, v20, v18
    v_perm_b32 v51, v20, v20, v19
    s_waitcnt vmcnt(19)
    v_mfma_f32_16x16x32_bf16 v[52:55], v[160:163], v[44:47], 0
    v_perm_b32 v44, v22, v22, v12
    v_perm_b32 v45, v22, v22, v13
    v_perm_b32 v46, v22, v22, v14
    v_perm_b32 v47, v22, v22, v15
    s_waitcnt vmcnt(18)
    v_mfma_f32_16x16x32_bf16 v[52:55], v[164:167], v[48:51], v[52:55]
    v_perm_b32 v48, v22, v22, v16
    v_perm_b32 v49, v22, v22, v17
    v_perm_b32 v50, v22, v22, v18
    v_perm_b32 v51, v22, v22, v19
    s_waitcnt vmcnt(17)
    v_mfma_f32_16x16x32_bf16 v[52:55], v[168:171], v[44:47], v[52:55]
    v_perm_b32 v44, v24, v24, v12
    v_perm_b32 v45, v24, v24, v13
    v_perm_b32 v46, v24, v24, v14
    v_perm_b32 v47, v24, v24, v15
    s_waitcnt vmcnt(16)
    v_mfma_f32_16x16x32_bf16 v[52:55], v[172:175], v[48:51], v[52:55]
    v_perm_b32 v48, v24, v24, v16
    v_perm_b32 v49, v24, v24, v17
    v_perm_b32 v50, v24, v24, v18
    v_perm_b32 v51, v24, v24, v19
    s_waitcnt vmcnt(15)
    v_mfma_f32_16x16x32_bf16 v[52:55], v[176:179], v[44:47], v[52:55]
    v_perm_b32 v44, v26, v26, v12
    v_perm_b32 v45, v26, v26, v13
    v_perm_b32 v46, v26, v26, v14
    v_perm_b32 v47, v26, v26, v15
    s_waitcnt vmcnt(14)
    v_mfma_f32_16x16x32_bf16 v[52:55], v[180:183], v[48:51], v[52:55]
    v_perm_b32 v48, v26, v26, v16
    v_perm_b32 v49, v26, v26, v17
    v_perm_b32 v50, v26, v26, v18
    v_perm_b32 v51, v26, v26, v19
    s_waitcnt vmcnt(13)
    v_mfma_f32_16x16x32_bf16 v[52:55], v[184:187], v[44:47], v[52:55]
    v_perm_b32 v44, v28, v28, v12
    v_perm_b32 v45, v28, v28, v13
    v_perm_b32 v46, v28, v28, v14
    v_perm_b32 v47, v28, v28, v15
    s_waitcnt vmcnt(12)
    v_mfma_f32_16x16x32_bf16 v[52:55], v[188:191], v[48:51], v[52:55]
    v_perm_b32 v48, v28, v28, v16
    v_perm_b32 v49, v28, v28, v17
    v_perm_b32 v50, v28, v28, v18
    v_perm_b32 v51, v28, v28, v19
    s_waitcnt vmcnt(11)
    v_mfma_f32_16x16x32_bf16 v[52:55], v[192:195], v[44:47], v[52:55]
    v_perm_b32 v44, v30, v30, v12
    v_perm_b32 v45, v30, v30, v13
    v_perm_b32 v46, v30, v30, v14
    v_perm_b32 v47, v30, v30, v15
    s_waitcnt vmcnt(10)
    v_mfma_f32_16x16x32_bf16 v[52:55], v[196:199], v[48:51], v[52:55]
    v_perm_b32 v48, v30, v30, v16
    v_perm_b32 v49, v30, v30, v17
    v_perm_b32 v50, v30, v30, v18
    v_perm_b32 v51, v30, v30, v19
    s_waitcnt vmcnt(9)
    v_mfma_f32_16x16x32_bf16 v[52:55], v[200:203], v[44:47], v[52:55]
    v_perm_b32 v44, v32, v32, v12
    v_perm_b32 v45, v32, v32, v13
    v_perm_b32 v46, v32, v32, v14
    v_perm_b32 v47, v32, v32, v15
    s_waitcnt vmcnt(8)
    v_mfma_f32_16x16x32_bf16 v[52:55], v[204:207], v[48:51], v[52:55]
    v_perm_b32 v48, v32, v32, v16
    v_perm_b32 v49, v32, v32, v17
    v_perm_b32 v50, v32, v32, v18
    v_perm_b32 v51, v32, v32, v19
    s_waitcnt vmcnt(7)
    v_mfma_f32_16x16x32_bf16 v[52:55], v[208:211], v[44:47], v[52:55]
    v_perm_b32 v44, v34, v34, v12
    v_perm_b32 v45, v34, v34, v13
    v_perm_b32 v46, v34, v34, v14
    v_perm_b32 v47, v34, v34, v15
    s_waitcnt vmcnt(6)
    v_mfma_f32_16x16x32_bf16 v[52:55], v[212:215], v[48:51], v[52:55]
    v_perm_b32 v48, v34, v34, v16
    v_perm_b32 v49, v34, v34, v17
    v_perm_b32 v50, v34, v34, v18
    v_perm_b32 v51, v34, v34, v19
    s_waitcnt vmcnt(5)
    v_mfma_f32_16x16x32_bf16 v[52:55], v[216:219], v[44:47], v[52:55]
    v_perm_b32 v44, v36, v36, v12
    v_perm_b32 v45, v36, v36, v13
    v_perm_b32 v46, v36, v36, v14
    v_perm_b32 v47, v36, v36, v15
    s_waitcnt vmcnt(4)
    v_mfma_f32_16x16x32_bf16 v[52:55], v[220:223], v[48:51], v[52:55]
    v_perm_b32 v48, v36, v36, v16
    v_perm_b32 v49, v36, v36, v17
    v_perm_b32 v50, v36, v36, v18
    v_perm_b32 v51, v36, v36, v19
    s_waitcnt vmcnt(3)
    v_mfma_f32_16x16x32_bf16 v[52:55], v[224:227], v[44:47], v[52:55]
    v_perm_b32 v44, v38, v38, v12
    v_perm_b32 v45, v38, v38, v13
    v_perm_b32 v46, v38, v38, v14
    v_perm_b32 v47, v38, v38, v15
    s_waitcnt vmcnt(2)
    v_mfma_f32_16x16x32_bf16 v[52:55], v[228:231], v[48:51], v[52:55]
    v_perm_b32 v48, v38, v38, v16
    v_perm_b32 v49, v38, v38, v17
    v_perm_b32 v50, v38, v38, v18
    v_perm_b32 v51, v38, v38, v19
    s_waitcnt vmcnt(1)
    v_mfma_f32_16x16x32_bf16 v[52:55], v[232:235], v[44:47], v[52:55]
    s_nop 1
    s_waitcnt vmcnt(0)
    v_mfma_f32_16x16x32_bf16 v[52:55], v[236:239], v[48:51], v[52:55]
    s_branch L_tail
L6_start:
    s_add_u32 s76, s83, 8192
    buffer_load_dwordx4 v[192:195], v61, s[56:59], s76 offen offset:0 nt
    buffer_load_dwordx4 v[196:199], v61, s[56:59], s76 offen offset:1024 nt
    buffer_load_dwordx4 v[200:203], v61, s[56:59], s76 offen offset:2048 nt
    buffer_load_dwordx4 v[204:207], v61, s[56:59], s76 offen offset:3072 nt
    s_add_u32 s76, s76, 4096
    buffer_load_dwordx4 v[208:211], v61, s[56:59], s76 offen offset:0 nt
    buffer_load_dwordx4 v[212:215], v61, s[56:59], s76 offen offset:1024 nt
    buffer_load_dwordx4 v[216:219], v61, s[56:59], s76 offen offset:2048 nt
    buffer_load_dwordx4 v[220:223], v61, s[56:59], s76 offen offset:3072 nt
    s_add_u32 s76, s76, 4096
    buffer_load_dwordx4 v[224:227], v61, s[56:59], s76 offen offset:0 nt
    buffer_load_dwordx4 v[228:231], v61, s[56:59], s76 offen offset:1024 nt
    buffer_load_dwordx4 v[232:235], v61, s[56:59], s76 offen offset:2048 nt
    buffer_load_dwordx4 v[236:239], v61, s[56:59], s76 offen offset:3072 nt
    s_add_u32 s76, s76, 4096
    buffer_load_dwordx4 v[240:243], v61, s[56:59], s76 offen offset:0 nt
    buffer_load_dwordx4 v[244:247], v61, s[56:59], s76 offen offset:1024 nt
    buffer_load_dwordx4 v[248:251], v61, s[56:59], s76 offen offset:2048 nt
    buffer_load_dwordx4 v[252:255], v61, s[56:59], s76 offen offset:3072 nt
    s_cmp_eq_u32 s11, 0
    s_cbranch_scc1 L6_poll
    s_add_u32 s76, s15, 0
    s_and_b32 s76, s76, 3
    s_mul_i32 s76, s76, 40960
    buffer_load_dwordx4 v[80:83], v63, s[64:67], s76 offen offset:0
    buffer_load_dwordx4 v[84:87], v63, s[64:67], s76 offen offset:256
    buffer_load_dwordx4 v[88:91], v63, s[64:67], s76 offen offset:512
    buffer_load_dwordx4 v[92:95], v63, s[64:67], s76 offen offset:768
    buffer_load_dwordx4 v[96:99], v63, s[64:67], s76 offen offset:1024
    s_add_u32 s76, s15, 1
    s_and_b32 s76, s76, 3
    s_mul_i32 s76, s76, 40960
    buffer_load_dwordx4 v[100:103], v63, s[64:67], s76 offen offset:0
    buffer_load_dwordx4 v[104:107], v63, s[64:67], s76 offen offset:256
    buffer_load_dwordx4 v[108:111], v63, s[64:67], s76 offen offset:512
    buffer_load_dwordx4 v[112:115], v63, s[64:67], s76 offen offset:768
    buffer_load_dwordx4 v[116:119], v63, s[64:67], s76 offen offset:1024
    s_add_u32 s76, s15, 2
    s_and_b32 s76, s76, 3
    s_mul_i32 s76, s76, 40960
    buffer_load_dwordx4 v[120:123], v63, s[64:67], s76 offen offset:0
    buffer_load_dwordx4 v[124:127], v63, s[64:67], s76 offen offset:256
    buffer_load_dwordx4 v[128:131], v63, s[64:67], s76 offen offset:512
    buffer_load_dwordx4 v[132:135], v63, s[64:67], s76 offen offset:768
    buffer_load_dwordx4 v[136:139], v63, s[64:67], s76 offen offset:1024
    s_add_u32 s76, s15, 3
    s_and_b32 s76, s76, 3
    s_mul_i32 s76, s76, 40960
    buffer_load_dwordx4 v[140:143], v63, s[64:67], s76 offen offset:0
    buffer_load_dwordx4 v[144:147], v63, s[64:67], s76 offen offset:256
    buffer_load_dwordx4 v[148:151], v63, s[64:67], s76 offen offset:512
    buffer_load_dwordx4 v[152:155], v63, s[64:67], s76 offen offset:768
    buffer_load_dwordx4 v[156:159], v63, s[64:67], s76 offen offset:1024
    s_branch L6_bar2
L6_poll:
    v_lshlrev_b32 v8, 4, v1
    s_mov_b64 exec, 0xffffffff
L6_fok:
    buffer_load_dwordx4 v[20:23], v8, s[88:91], 0 offen offset:0 sc1
    buffer_load_dwordx4 v[24:27], v8, s[88:91], 0 offen offset:512 sc1
    s_cmp_eq_u32 s12, 0
    s_cbranch_scc1 L6_pA
    buffer_load_dwordx4 v[28:31], v8, s[88:91], 0 offen offset:1024 sc1
    buffer_load_dwordx4 v[32:35], v8, s[88:91], 0 offen offset:1536 sc1
    buffer_load_dwordx4 v[36:39], v8, s[88:91], 0 offen offset:2048 sc1
    buffer_load_dwordx4 v[40:43], v8, s[88:91], 0 offen offset:2560 sc1
    s_waitcnt vmcnt(0)
    v_xor_b32 v44, s94, v20
    v_xor_b32 v45, s95, v21
    v_xor_b32 v46, s96, v22
    v_xor_b32 v47, s98, v23
    v_or3_b32 v7, v44, v45, v46
    v_or_b32 v7, v7, v47
    v_xor_b32 v44, s94, v24
    v_xor_b32 v45, s95, v25
    v_xor_b32 v46, s96, v26
    v_xor_b32 v47, s98, v27
    v_or3_b32 v7, v7, v44, v45
    v_or3_b32 v7, v7, v46, v47
    v_xor_b32 v44, s94, v28
    v_xor_b32 v45, s95, v29
    v_xor_b32 v46, s96, v30
    v_xor_b32 v47, s98, v31
    v_or3_b32 v7, v7, v44, v45
    v_or3_b32 v7, v7, v46, v47
    v_xor_b32 v44, s94, v32
    v_xor_b32 v45, s95, v33
    v_xor_b32 v46, s96, v34
    v_xor_b32 v47, s98, v35
    v_or3_b32 v7, v7, v44, v45
    v_or3_b32 v7, v7, v46, v47
    v_xor_b32 v44, s94, v36
    v_xor_b32 v45, s95, v37
    v_xor_b32 v46, s96, v38
    v_xor_b32 v47, s98, v39
    v_or3_b32 v7, v7, v44, v45
    v_or3_b32 v7, v7, v46, v47
    v_xor_b32 v44, s94, v40
    v_xor_b32 v45, s95, v41
    v_xor_b32 v46, s96, v42
    v_xor_b32 v47, s98, v43
    v_or3_b32 v7, v7, v44, v45
    v_or3_b32 v7, v7, v46, v47
    v_and_b32 v7, 0xfff, v7
    v_cmp_ne_u32 vcc, 0, v7
    s_cbranch_vccz L6_qokB
    s_sleep 2
    s_branch L6_fok
L6_qokB:
    v_add_f32 v20, v20, v24
    v_add_f32 v28, v28, v32
    v_add_f32 v36, v36, v40
    v_add_f32 v21, v21, v25
    v_add_f32 v29, v29, v33
    v_add_f32 v37, v37, v41
    v_add_f32 v22, v22, v26
    v_add_f32 v30, v30, v34
    v_add_f32 v38, v38, v42
    v_add_f32 v23, v23, v27
    v_add_f32 v31, v31, v35
    v_add_f32 v39, v39, v43
    v_add_f32 v20, v20, v28
    v_add_f32 v21, v21, v29
    v_add_f32 v22, v22, v30
    v_add_f32 v23, v23, v31
    v_add_f32 v20, v20, v36
    v_add_f32 v21, v21, v37
    v_add_f32 v22, v22, v38
    v_add_f32 v23, v23, v39
    s_branch L6_qsum
L6_pA:
    s_waitcnt vmcnt(0)
    v_xor_b32 v44, s94, v20
    v_xor_b32 v45, s95, v21
    v_xor_b32 v46, s96, v22
    v_xor_b32 v47, s98, v23
    v_or3_b32 v7, v44, v45, v46
    v_or_b32 v7, v7, v47
    v_xor_b32 v44, s94, v24
    v_xor_b32 v45, s95, v25
    v_xor_b32 v46, s96, v26
    v_xor_b32 v47, s98, v27
    v_or3_b32 v7, v7, v44, v45
    v_or3_b32 v7, v7, v46, v47
    v_and_b32 v7, 0xfff, v7
    v_cmp_ne_u32 vcc, 0, v7
    s_cbranch_vccz L6_qokA
    s_sleep 2
    s_branch L6_fok
L6_qokA:
    v_add_f32 v20, v20, v24
    v_add_f32 v21, v21, v25
    v_add_f32 v22, v22, v26
    v_add_f32 v23, v23, v27
L6_qsum:
    v_cvt_pk_bf16_f32 v20, v20, v21
    v_cvt_pk_bf16_f32 v22, v22, v23
    v_lshrrev_b32 v6, 3, v1
    v_lshlrev_b32 v6, 6, v6
    v_and_b32 v7, 7, v1
    v_lshl_add_u32 v6, v7, 1, v6
    ds_write_b16 v6, v20 offset:4096
    ds_write_b16_d16_hi v6, v20 offset:4112
    ds_write_b16 v6, v22 offset:4128
    ds_write_b16_d16_hi v6, v22 offset:4144
    s_mov_b64 exec, -1
    s_waitcnt lgkmcnt(0)
L6_bar2:
    s_barrier
    v_and_b32 v4, 3, v2
    v_lshl_add_u32 v4, v3, 2, v4
    v_lshlrev_b32 v4, 4, v4
    ds_read_b128 v[44:47], v4 offset:4096
    s_cmp_lg_u32 s11, 0
    s_cbranch_scc1 L6_wodone
    s_add_u32 s76, s15, 0
    s_and_b32 s76, s76, 3
    s_mul_i32 s76, s76, 40960
    buffer_load_dwordx4 v[80:83], v63, s[64:67], s76 offen offset:0
    buffer_load_dwordx4 v[84:87], v63, s[64:67], s76 offen offset:256
    buffer_load_dwordx4 v[88:91], v63, s[64:67], s76 offen offset:512
    buffer_load_dwordx4 v[92:95], v63, s[64:67], s76 offen offset:768
    buffer_load_dwordx4 v[96:99], v63, s[64:67], s76 offen offset:1024
    s_add_u32 s76, s15, 1
    s_and_b32 s76, s76, 3
    s_mul_i32 s76, s76, 40960
    buffer_load_dwordx4 v[100:103], v63, s[64:67], s76 offen offset:0
    buffer_load_dwordx4 v[104:107], v63, s[64:67], s76 offen offset:256
    buffer_load_dwordx4 v[108:111], v63, s[64:67], s76 offen offset:512
    buffer_load_dwordx4 v[112:115], v63, s[64:67], s76 offen offset:768
    buffer_load_dwordx4 v[116:119], v63, s[64:67], s76 offen offset:1024
    s_add_u32 s76, s15, 2
    s_and_b32 s76, s76, 3
    s_mul_i32 s76, s76, 40960
    buffer_load_dwordx4 v[120:123], v63, s[64:67], s76 offen offset:0
    buffer_load_dwordx4 v[124:127], v63, s[64:67], s76 offen offset:256
    buffer_load_dwordx4 v[128:131], v63, s[64:67], s76 offen offset:512
    buffer_load_dwordx4 v[132:135], v63, s[64:67], s76 offen offset:768
    buffer_load_dwordx4 v[136:139], v63, s[64:67], s76 offen offset:1024
    s_add_u32 s76, s15, 3
    s_and_b32 s76, s76, 3
    s_mul_i32 s76, s76, 40960
    buffer_load_dwordx4 v[140:143], v63, s[64:67], s76 offen offset:0
    buffer_load_dwordx4 v[144:147], v63, s[64:67], s76 offen offset:256
    buffer_load_dwordx4 v[148:151], v63, s[64:67], s76 offen offset:512
    buffer_load_dwordx4 v[152:155], v63, s[64:67], s76 offen offset:768
    buffer_load_dwordx4 v[156:159], v63, s[64:67], s76 offen offset:1024
L6_wodone:
    s_waitcnt lgkmcnt(0)
    s_mov_b32 s76, s83
    s_waitcnt vmcnt(40)
    v_mfma_f32_16x16x32_bf16 v[48:51], v[160:163], v[44:47], 0
    v_mfma_f32_16x16x32_bf16 v[52:55], v[164:167], v[44:47], 0
    v_mfma_f32_16x16x32_bf16 v[56:59], v[168:171], v[44:47], 0
    v_mfma_f32_16x16x32_bf16 v[76:79], v[172:175], v[44:47], 0
    buffer_load_dwordx4 v[160:163], v62, s[60:63], s76 offen offset:0 nt
    buffer_load_dwordx4 v[164:167], v62, s[60:63], s76 offen offset:1024 nt
    buffer_load_dwordx4 v[168:171], v62, s[60:63], s76 offen offset:2048 nt
    buffer_load_dwordx4 v[172:175], v62, s[60:63], s76 offen offset:3072 nt
    s_nop 1
    v_mov_b32_dpp v20, v48 quad_perm:[0,0,0,0] row_mask:0xf bank_mask:0xf
    v_mov_b32_dpp v21, v52 quad_perm:[0,0,0,0] row_mask:0xf bank_mask:0xf
    v_mov_b32_dpp v22, v56 quad_perm:[0,0,0,0] row_mask:0xf bank_mask:0xf
    v_mov_b32_dpp v23, v76 quad_perm:[0,0,0,0] row_mask:0xf bank_mask:0xf
    v_add_f32_dpp v20, v49, v20 quad_perm:[1,1,1,1] row_mask:0xf bank_mask:0xf
    v_add_f32_dpp v21, v53, v21 quad_perm:[1,1,1,1] row_mask:0xf bank_mask:0xf
    v_add_f32_dpp v22, v57, v22 quad_perm:[1,1,1,1] row_mask:0xf bank_mask:0xf
    v_add_f32_dpp v23, v77, v23 quad_perm:[1,1,1,1] row_mask:0xf bank_mask:0xf
    v_add_f32_dpp v20, v50, v20 quad_perm:[2,2,2,2] row_mask:0xf bank_mask:0xf
    v_add_f32_dpp v21, v54, v21 quad_perm:[2,2,2,2] row_mask:0xf bank_mask:0xf
    v_add_f32_dpp v22, v58, v22 quad_perm:[2,2,2,2] row_mask:0xf bank_mask:0xf
    v_add_f32_dpp v23, v78, v23 quad_perm:[2,2,2,2] row_mask:0xf bank_mask:0xf
    v_add_f32_dpp v20, v51, v20 quad_perm:[3,3,3,3] row_mask:0xf bank_mask:0xf
    v_add_f32_dpp v21, v55, v21 quad_perm:[3,3,3,3] row_mask:0xf bank_mask:0xf
    v_add_f32_dpp v22, v59, v22 quad_perm:[3,3,3,3] row_mask:0xf bank_mask:0xf
    v_add_f32_dpp v23, v79, v23 quad_perm:[3,3,3,3] row_mask:0xf bank_mask:0xf
    s_add_u32 s76, s76, 4096
    s_waitcnt vmcnt(40)
    v_mfma_f32_16x16x32_bf16 v[48:51], v[176:179], v[44:47], 0
    v_mfma_f32_16x16x32_bf16 v[52:55], v[180:183], v[44:47], 0
    v_mfma_f32_16x16x32_bf16 v[56:59], v[184:187], v[44:47], 0
    v_mfma_f32_16x16x32_bf16 v[76:79], v[188:191], v[44:47], 0
    buffer_load_dwordx4 v[176:179], v62, s[60:63], s76 offen offset:0 nt
    buffer_load_dwordx4 v[180:183], v62, s[60:63], s76 offen offset:1024 nt
    buffer_load_dwordx4 v[184:187], v62, s[60:63], s76 offen offset:2048 nt
    buffer_load_dwordx4 v[188:191], v62, s[60:63], s76 offen offset:3072 nt
    s_nop 1
    v_mov_b32_dpp v24, v48 quad_perm:[0,0,0,0] row_mask:0xf bank_mask:0xf
    v_mov_b32_dpp v25, v52 quad_perm:[0,0,0,0] row_mask:0xf bank_mask:0xf
    v_mov_b32_dpp v26, v56 quad_perm:[0,0,0,0] row_mask:0xf bank_mask:0xf
    v_mov_b32_dpp v27, v76 quad_perm:[0,0,0,0] row_mask:0xf bank_mask:0xf
    v_add_f32_dpp v24, v49, v24 quad_perm:[1,1,1,1] row_mask:0xf bank_mask:0xf
    v_add_f32_dpp v25, v53, v25 quad_perm:[1,1,1,1] row_mask:0xf bank_mask:0xf
    v_add_f32_dpp v26, v57, v26 quad_perm:[1,1,1,1] row_mask:0xf bank_mask:0xf
    v_add_f32_dpp v27, v77, v27 quad_perm:[1,1,1,1] row_mask:0xf bank_mask:0xf
    v_add_f32_dpp v24, v50, v24 quad_perm:[2,2,2,2] row_mask:0xf bank_mask:0xf
    v_add_f32_dpp v25, v54, v25 quad_perm:[2,2,2,2] row_mask:0xf bank_mask:0xf
    v_add_f32_dpp v26, v58, v26 quad_perm:[2,2,2,2] row_mask:0xf bank_mask:0xf
    v_add_f32_dpp v27, v78, v27 quad_perm:[2,2,2,2] row_mask:0xf bank_mask:0xf
    v_add_f32_dpp v24, v51, v24 quad_perm:[3,3,3,3] row_mask:0xf bank_mask:0xf
    v_add_f32_dpp v25, v55, v25 quad_perm:[3,3,3,3] row_mask:0xf bank_mask:0xf
    v_add_f32_dpp v26, v59, v26 quad_perm:[3,3,3,3] row_mask:0xf bank_mask:0xf
    v_add_f32_dpp v27, v79, v27 quad_perm:[3,3,3,3] row_mask:0xf bank_mask:0xf
    s_add_u32 s76, s76, 4096
    s_waitcnt vmcnt(40)
    v_mfma_f32_16x16x32_bf16 v[48:51], v[192:195], v[44:47], 0
    v_mfma_f32_16x16x32_bf16 v[52:55], v[196:199], v[44:47], 0
    v_mfma_f32_16x16x32_bf16 v[56:59], v[200:203], v[44:47], 0
    v_mfma_f32_16x16x32_bf16 v[76:79], v[204:207], v[44:47], 0
    buffer_load_dwordx4 v[192:195], v62, s[60:63], s76 offen offset:0 nt
    buffer_load_dwordx4 v[196:199], v62, s[60:63], s76 offen offset:1024 nt
    buffer_load_dwordx4 v[200:203], v62, s[60:63], s76 offen offset:2048 nt
    buffer_load_dwordx4 v[204:207], v62, s[60:63], s76 offen offset:3072 nt
    s_nop 1
    v_mov_b32_dpp v28, v48 quad_perm:[0,0,0,0] row_mask:0xf bank_mask:0xf
    v_mov_b32_dpp v29, v52 quad_perm:[0,0,0,0] row_mask:0xf bank_mask:0xf
    v_mov_b32_dpp v30, v56 quad_perm:[0,0,0,0] row_mask:0xf bank_mask:0xf
    v_mov_b32_dpp v31, v76 quad_perm:[0,0,0,0] row_mask:0xf bank_mask:0xf
    v_add_f32_dpp v28, v49, v28 quad_perm:[1,1,1,1] row_mask:0xf bank_mask:0xf
    v_add_f32_dpp v29, v53, v29 quad_perm:[1,1,1,1] row_mask:0xf bank_mask:0xf
    v_add_f32_dpp v30, v57, v30 quad_perm:[1,1,1,1] row_mask:0xf bank_mask:0xf
    v_add_f32_dpp v31, v77, v31 quad_perm:[1,1,1,1] row_mask:0xf bank_mask:0xf
    v_add_f32_dpp v28, v50, v28 quad_perm:[2,2,2,2] row_mask:0xf bank_mask:0xf
    v_add_f32_dpp v29, v54, v29 quad_perm:[2,2,2,2] row_mask:0xf bank_mask:0xf
    v_add_f32_dpp v30, v58, v30 quad_perm:[2,2,2,2] row_mask:0xf bank_mask:0xf
    v_add_f32_dpp v31, v78, v31 quad_perm:[2,2,2,2] row_mask:0xf bank_mask:0xf
    v_add_f32_dpp v28, v51, v28 quad_perm:[3,3,3,3] row_mask:0xf bank_mask:0xf
    v_add_f32_dpp v29, v55, v29 quad_perm:[3,3,3,3] row_mask:0xf bank_mask:0xf
    v_add_f32_dpp v30, v59, v30 quad_perm:[3,3,3,3] row_mask:0xf bank_mask:0xf
    v_add_f32_dpp v31, v79, v31 quad_perm:[3,3,3,3] row_mask:0xf bank_mask:0xf
    s_add_u32 s76, s76, 4096
    s_waitcnt vmcnt(40)
    v_mfma_f32_16x16x32_bf16 v[48:51], v[208:211], v[44:47], 0
    v_mfma_f32_16x16x32_bf16 v[52:55], v[212:215], v[44:47], 0
    v_mfma_f32_16x16x32_bf16 v[56:59], v[216:219], v[44:47], 0
    v_mfma_f32_16x16x32_bf16 v[76:79], v[220:223], v[44:47], 0
    buffer_load_dwordx4 v[208:211], v62, s[60:63], s76 offen offset:0 nt
    buffer_load_dwordx4 v[212:215], v62, s[60:63], s76 offen offset:1024 nt
    buffer_load_dwordx4 v[216:219], v62, s[60:63], s76 offen offset:2048 nt
    buffer_load_dwordx4 v[220:223], v62, s[60:63], s76 offen offset:3072 nt
    s_nop 1
    v_mov_b32_dpp v32, v48 quad_perm:[0,0,0,0] row_mask:0xf bank_mask:0xf
    v_mov_b32_dpp v33, v52 quad_perm:[0,0,0,0] row_mask:0xf bank_mask:0xf
    v_mov_b32_dpp v34, v56 quad_perm:[0,0,0,0] row_mask:0xf bank_mask:0xf
    v_mov_b32_dpp v35, v76 quad_perm:[0,0,0,0] row_mask:0xf bank_mask:0xf
    v_add_f32_dpp v32, v49, v32 quad_perm:[1,1,1,1] row_mask:0xf bank_mask:0xf
    v_add_f32_dpp v33, v53, v33 quad_perm:[1,1,1,1] row_mask:0xf bank_mask:0xf
    v_add_f32_dpp v34, v57, v34 quad_perm:[1,1,1,1] row_mask:0xf bank_mask:0xf
    v_add_f32_dpp v35, v77, v35 quad_perm:[1,1,1,1] row_mask:0xf bank_mask:0xf
    v_add_f32_dpp v32, v50, v32 quad_perm:[2,2,2,2] row_mask:0xf bank_mask:0xf
    v_add_f32_dpp v33, v54, v33 quad_perm:[2,2,2,2] row_mask:0xf bank_mask:0xf
    v_add_f32_dpp v34, v58, v34 quad_perm:[2,2,2,2] row_mask:0xf bank_mask:0xf
    v_add_f32_dpp v35, v78, v35 quad_perm:[2,2,2,2] row_mask:0xf bank_mask:0xf
    v_add_f32_dpp v32, v51, v32 quad_perm:[3,3,3,3] row_mask:0xf bank_mask:0xf
    v_add_f32_dpp v33, v55, v33 quad_perm:[3,3,3,3] row_mask:0xf bank_mask:0xf
    v_add_f32_dpp v34, v59, v34 quad_perm:[3,3,3,3] row_mask:0xf bank_mask:0xf
    v_add_f32_dpp v35, v79, v35 quad_perm:[3,3,3,3] row_mask:0xf bank_mask:0xf
    s_add_u32 s76, s76, 4096
    s_waitcnt vmcnt(40)
    v_mfma_f32_16x16x32_bf16 v[48:51], v[224:227], v[44:47], 0
    v_mfma_f32_16x16x32_bf16 v[52:55], v[228:231], v[44:47], 0
    v_mfma_f32_16x16x32_bf16 v[56:59], v[232:235], v[44:47], 0
    v_mfma_f32_16x16x32_bf16 v[76:79], v[236:239], v[44:47], 0
    buffer_load_dwordx4 v[224:227], v62, s[60:63], s76 offen offset:0 nt
    buffer_load_dwordx4 v[228:231], v62, s[60:63], s76 offen offset:1024 nt
    buffer_load_dwordx4 v[232:235], v62, s[60:63], s76 offen offset:2048 nt
    buffer_load_dwordx4 v[236:239], v62, s[60:63], s76 offen offset:3072 nt
    s_nop 1
    v_mov_b32_dpp v36, v48 quad_perm:[0,0,0,0] row_mask:0xf bank_mask:0xf
    v_mov_b32_dpp v37, v52 quad_perm:[0,0,0,0] row_mask:0xf bank_mask:0xf
    v_mov_b32_dpp v38, v56 quad_perm:[0,0,0,0] row_mask:0xf bank_mask:0xf
    v_mov_b32_dpp v39, v76 quad_perm:[0,0,0,0] row_mask:0xf bank_mask:0xf
    v_add_f32_dpp v36, v49, v36 quad_perm:[1,1,1,1] row_mask:0xf bank_mask:0xf
    v_add_f32_dpp v37, v53, v37 quad_perm:[1,1,1,1] row_mask:0xf bank_mask:0xf
    v_add_f32_dpp v38, v57, v38 quad_perm:[1,1,1,1] row_mask:0xf bank_mask:0xf
    v_add_f32_dpp v39, v77, v39 quad_perm:[1,1,1,1] row_mask:0xf bank_mask:0xf
    v_add_f32_dpp v36, v50, v36 quad_perm:[2,2,2,2] row_mask:0xf bank_mask:0xf
    v_add_f32_dpp v37, v54, v37 quad_perm:[2,2,2,2] row_mask:0xf bank_mask:0xf
    v_add_f32_dpp v38, v58, v38 quad_perm:[2,2,2,2] row_mask:0xf bank_mask:0xf
    v_add_f32_dpp v39, v78, v39 quad_perm:[2,2,2,2] row_mask:0xf bank_mask:0xf
    v_add_f32_dpp v36, v51, v36 quad_perm:[3,3,3,3] row_mask:0xf bank_mask:0xf
    v_add_f32_dpp v37, v55, v37 quad_perm:[3,3,3,3] row_mask:0xf bank_mask:0xf
    v_add_f32_dpp v38, v59, v38 quad_perm:[3,3,3,3] row_mask:0xf bank_mask:0xf
    v_add_f32_dpp v39, v79, v39 quad_perm:[3,3,3,3] row_mask:0xf bank_mask:0xf
    s_add_u32 s76, s76, 4096
    s_waitcnt vmcnt(40)
    v_mfma_f32_16x16x32_bf16 v[48:51], v[240:243], v[44:47], 0
    v_mfma_f32_16x16x32_bf16 v[52:55], v[244:247], v[44:47], 0
    v_mfma_f32_16x16x32_bf16 v[56:59], v[248:251], v[44:47], 0
    v_mfma_f32_16x16x32_bf16 v[76:79], v[252:255], v[44:47], 0
    buffer_load_dwordx4 v[240:243], v62, s[60:63], s76 offen offset:0 nt
    buffer_load_dwordx4 v[244:247], v62, s[60:63], s76 offen offset:1024 nt
    buffer_load_dwordx4 v[248:251], v62, s[60:63], s76 offen offset:2048 nt
    buffer_load_dwordx4 v[252:255], v62, s[60:63], s76 offen offset:3072 nt
    s_nop 1
    v_mov_b32_dpp v40, v48 quad_perm:[0,0,0,0] row_mask:0xf bank_mask:0xf
    v_mov_b32_dpp v41, v52 quad_perm:[0,0,0,0] row_mask:0xf bank_mask:0xf
    v_mov_b32_dpp v42, v56 quad_perm:[0,0,0,0] row_mask:0xf bank_mask:0xf
    v_mov_b32_dpp v43, v76 quad_perm:[0,0,0,0] row_mask:0xf bank_mask:0xf
    v_add_f32_dpp v40, v49, v40 quad_perm:[1,1,1,1] row_mask:0xf bank_mask:0xf
    v_add_f32_dpp v41, v53, v41 quad_perm:[1,1,1,1] row_mask:0xf bank_mask:0xf
    v_add_f32_dpp v42, v57, v42 quad_perm:[1,1,1,1] row_mask:0xf bank_mask:0xf
    v_add_f32_dpp v43, v77, v43 quad_perm:[1,1,1,1] row_mask:0xf bank_mask:0xf
    v_add_f32_dpp v40, v50, v40 quad_perm:[2,2,2,2] row_mask:0xf bank_mask:0xf
    v_add_f32_dpp v41, v54, v41 quad_perm:[2,2,2,2] row_mask:0xf bank_mask:0xf
    v_add_f32_dpp v42, v58, v42 quad_perm:[2,2,2,2] row_mask:0xf bank_mask:0xf
    v_add_f32_dpp v43, v78, v43 quad_perm:[2,2,2,2] row_mask:0xf bank_mask:0xf
    v_add_f32_dpp v40, v51, v40 quad_perm:[3,3,3,3] row_mask:0xf bank_mask:0xf
    v_add_f32_dpp v41, v55, v41 quad_perm:[3,3,3,3] row_mask:0xf bank_mask:0xf
    v_add_f32_dpp v42, v59, v42 quad_perm:[3,3,3,3] row_mask:0xf bank_mask:0xf
    v_add_f32_dpp v43, v79, v43 quad_perm:[3,3,3,3] row_mask:0xf bank_mask:0xf
    v_max3_f32 v4, v20, v21, v22
    v_max3_f32 v4, v4, v23, v24
    v_max3_f32 v4, v4, v25, v26
    v_max3_f32 v4, v4, v27, v28
    v_max3_f32 v4, v4, v29, v30
    v_max3_f32 v4, v4, v31, v32
    v_max3_f32 v4, v4, v33, v34
    v_max3_f32 v4, v4, v35, v36
    v_max3_f32 v4, v4, v37, v38
    v_max3_f32 v4, v4, v39, v40
    v_max3_f32 v4, v4, v41, v42
    v_max_f32 v4, v4, v43
    s_nop 0
    v_readlane_b32 s76, v4, 0
    v_readlane_b32 s77, v4, 16
    v_readlane_b32 s78, v4, 32
    v_readlane_b32 s79, v4, 48
    s_nop 1
    v_mov_b32 v4, s76
    v_max_f32 v4, s77, v4
    v_max_f32 v4, s78, v4
    v_max_f32 v4, s79, v4
    s_lshl_b32 s76, s11, 2
    v_mov_b32 v5, s76
    ds_write_b32 v5, v4 offset:4352
    s_waitcnt lgkmcnt(0)
    s_barrier
    v_mov_b32 v5, 0
    ds_read_b128 v[44:47], v5 offset:4352
    ds_read_b128 v[48:51], v5 offset:4368
    s_waitcnt lgkmcnt(0)
    v_max3_f32 v4, v44, v45, v46
    v_max3_f32 v4, v4, v47, v48
    v_max3_f32 v4, v4, v49, v50
    v_max_f32 v4, v4, v51
    v_mul_f32 v65, s82, v4
    v_fma_f32 v20, v20, s82, -v65
    v_fma_f32 v21, v21, s82, -v65
    v_fma_f32 v22, v22, s82, -v65
    v_fma_f32 v23, v23, s82, -v65
    v_fma_f32 v24, v24, s82, -v65
    v_fma_f32 v25, v25, s82, -v65
    v_fma_f32 v26, v26, s82, -v65
    v_fma_f32 v27, v27, s82, -v65
    v_fma_f32 v28, v28, s82, -v65
    v_fma_f32 v29, v29, s82, -v65
    v_fma_f32 v30, v30, s82, -v65
    v_fma_f32 v31, v31, s82, -v65
    v_fma_f32 v32, v32, s82, -v65
    v_fma_f32 v33, v33, s82, -v65
    v_fma_f32 v34, v34, s82, -v65
    v_fma_f32 v35, v35, s82, -v65
    v_fma_f32 v36, v36, s82, -v65
    v_fma_f32 v37, v37, s82, -v65
    v_fma_f32 v38, v38, s82, -v65
    v_fma_f32 v39, v39, s82, -v65
    v_fma_f32 v40, v40, s82, -v65
    v_fma_f32 v41, v41, s82, -v65
    v_fma_f32 v42, v42, s82, -v65
    v_fma_f32 v43, v43, s82, -v65
    v_exp_f32 v20, v20
    v_exp_f32 v21, v21
    v_exp_f32 v22, v22
    v_exp_f32 v23, v23
    v_exp_f32 v24, v24
    v_exp_f32 v25, v25
    v_exp_f32 v26, v26
    v_exp_f32 v27, v27
    v_exp_f32 v28, v28
    v_exp_f32 v29, v29
    v_exp_f32 v30, v30
    v_exp_f32 v31, v31
    v_exp_f32 v32, v32
    v_exp_f32 v33, v33
    v_exp_f32 v34, v34
    v_exp_f32 v35, v35
    v_exp_f32 v36, v36
    v_exp_f32 v37, v37
    v_exp_f32 v38, v38
    v_exp_f32 v39, v39
    v_exp_f32 v40, v40
    v_exp_f32 v41, v41
    v_exp_f32 v42, v42
    v_exp_f32 v43, v43
    s_nop 0
    v_add_f32 v64, v20, v21
    v_add_f32 v64, v64, v22
    v_add_f32 v64, v64, v23
    v_add_f32 v64, v64, v24
    v_add_f32 v64, v64, v25
    v_add_f32 v64, v64, v26
    v_add_f32 v64, v64, v27
    v_add_f32 v64, v64, v28
    v_add_f32 v64, v64, v29
    v_add_f32 v64, v64, v30
    v_add_f32 v64, v64, v31
    v_add_f32 v64, v64, v32
    v_add_f32 v64, v64, v33
    v_add_f32 v64, v64, v34
    v_add_f32 v64, v64, v35
    v_add_f32 v64, v64, v36
    v_add_f32 v64, v64, v37
    v_add_f32 v64, v64, v38
    v_add_f32 v64, v64, v39
    v_add_f32 v64, v64, v40
    v_add_f32 v64, v64, v41
    v_add_f32 v64, v64, v42
    v_add_f32 v64, v64, v43
    s_lshl_b32 s76, s11, 4
    v_lshlrev_b32 v4, 2, v3
    v_add_u32 v4, s76, v4
    s_mov_b64 exec, s[84:85]
    ds_write_b32 v4, v64 offset:4384
    s_mov_b64 exec, -1
    v_cvt_pk_bf16_f32 v20, v20, v21
    v_cvt_pk_bf16_f32 v22, v22, v23
    v_cvt_pk_bf16_f32 v24, v24, v25
    v_cvt_pk_bf16_f32 v26, v26, v27
    v_cvt_pk_bf16_f32 v28, v28, v29
    v_cvt_pk_bf16_f32 v30, v30, v31
    v_cvt_pk_bf16_f32 v32, v32, v33
    v_cvt_pk_bf16_f32 v34, v34, v35
    v_cvt_pk_bf16_f32 v36, v36, v37
    v_cvt_pk_bf16_f32 v38, v38, v39
    v_cvt_pk_bf16_f32 v40, v40, v41
    v_cvt_pk_bf16_f32 v42, v42, v43
    s_waitcnt lgkmcnt(0)
    s_barrier
    v_lshlrev_b32 v4, 2, v1
    v_and_b32 v4, 127, v4
    ds_read_b32 v5, v4 offset:4384
    s_waitcnt lgkmcnt(0)
    s_nop 1
    v_add_f32_dpp v5, v5, v5 quad_perm:[1,0,3,2] row_mask:0xf bank_mask:0xf
    s_nop 1
    v_add_f32_dpp v5, v5, v5 quad_perm:[2,3,0,1] row_mask:0xf bank_mask:0xf
    s_nop 1
    v_add_f32_dpp v5, v5, v5 row_half_mirror row_mask:0xf bank_mask:0xf
    s_nop 1
    v_add_f32_dpp v5, v5, v5 row_mirror row_mask:0xf bank_mask:0xf
    s_nop 1
    v_readlane_b32 s76, v5, 16
    s_nop 1
    v_add_f32 v5, s76, v5
    v_mov_b32 v72, v65
    v_mov_b32 v73, v5
    v_mov_b32 v74, s42
    v_mov_b32 v75, s43
    v_perm_b32 v44, v20, v20, v12
    v_perm_b32 v45, v20, v20, v13
    v_perm_b32 v46, v20, v20, v14
    v_perm_b32 v47, v20, v20, v15
    v_perm_b32 v48, v20, v20, v16
    v_perm_b32 v49, v20, v20, v17
    v_perm_b32 v50, v20, v20, v18
    v_perm_b32 v51, v20, v20, v19
    s_waitcnt vmcnt(23)
    v_mfma_f32_16x16x32_bf16 v[52:55], v[160:163], v[44:47], 0
    v_perm_b32 v44, v22, v22, v12
    v_perm_b32 v45, v22, v22, v13
    v_perm_b32 v46, v22, v22, v14
    v_perm_b32 v47, v22, v22, v15
    s_waitcnt vmcnt(22)
    v_mfma_f32_16x16x32_bf16 v[52:55], v[164:167], v[48:51], v[52:55]
    v_perm_b32 v48, v22, v22, v16
    v_perm_b32 v49, v22, v22, v17
    v_perm_b32 v50, v22, v22, v18
    v_perm_b32 v51, v22, v22, v19
    s_waitcnt vmcnt(21)
    v_mfma_f32_16x16x32_bf16 v[52:55], v[168:171], v[44:47], v[52:55]
    v_perm_b32 v44, v24, v24, v12
    v_perm_b32 v45, v24, v24, v13
    v_perm_b32 v46, v24, v24, v14
    v_perm_b32 v47, v24, v24, v15
    s_waitcnt vmcnt(20)
    v_mfma_f32_16x16x32_bf16 v[52:55], v[172:175], v[48:51], v[52:55]
    v_perm_b32 v48, v24, v24, v16
    v_perm_b32 v49, v24, v24, v17
    v_perm_b32 v50, v24, v24, v18
    v_perm_b32 v51, v24, v24, v19
    s_waitcnt vmcnt(19)
    v_mfma_f32_16x16x32_bf16 v[52:55], v[176:179], v[44:47], v[52:55]
    v_perm_b32 v44, v26, v26, v12
    v_perm_b32 v45, v26, v26, v13
    v_perm_b32 v46, v26, v26, v14
    v_perm_b32 v47, v26, v26, v15
    s_waitcnt vmcnt(18)
    v_mfma_f32_16x16x32_bf16 v[52:55], v[180:183], v[48:51], v[52:55]
    v_perm_b32 v48, v26, v26, v16
    v_perm_b32 v49, v26, v26, v17
    v_perm_b32 v50, v26, v26, v18
    v_perm_b32 v51, v26, v26, v19
    s_waitcnt vmcnt(17)
    v_mfma_f32_16x16x32_bf16 v[52:55], v[184:187], v[44:47], v[52:55]
    v_perm_b32 v44, v28, v28, v12
    v_perm_b32 v45, v28, v28, v13
    v_perm_b32 v46, v28, v28, v14
    v_perm_b32 v47, v28, v28, v15
    s_waitcnt vmcnt(16)
    v_mfma_f32_16x16x32_bf16 v[52:55], v[188:191], v[48:51], v[52:55]
    v_perm_b32 v48, v28, v28, v16
    v_perm_b32 v49, v28, v28, v17
    v_perm_b32 v50, v28, v28, v18
    v_perm_b32 v51, v28, v28, v19
    s_waitcnt vmcnt(15)
    v_mfma_f32_16x16x32_bf16 v[52:55], v[192:195], v[44:47], v[52:55]
    v_perm_b32 v44, v30, v30, v12
    v_perm_b32 v45, v30, v30, v13
    v_perm_b32 v46, v30, v30, v14
    v_perm_b32 v47, v30, v30, v15
    s_waitcnt vmcnt(14)
    v_mfma_f32_16x16x32_bf16 v[52:55], v[196:199], v[48:51], v[52:55]
    v_perm_b32 v48, v30, v30, v16
    v_perm_b32 v49, v30, v30, v17
    v_perm_b32 v50, v30, v30, v18
    v_perm_b32 v51, v30, v30, v19
    s_waitcnt vmcnt(13)
    v_mfma_f32_16x16x32_bf16 v[52:55], v[200:203], v[44:47], v[52:55]
    v_perm_b32 v44, v32, v32, v12
    v_perm_b32 v45, v32, v32, v13
    v_perm_b32 v46, v32, v32, v14
    v_perm_b32 v47, v32, v32, v15
    s_waitcnt vmcnt(12)
    v_mfma_f32_16x16x32_bf16 v[52:55], v[204:207], v[48:51], v[52:55]
    v_perm_b32 v48, v32, v32, v16
    v_perm_b32 v49, v32, v32, v17
    v_perm_b32 v50, v32, v32, v18
    v_perm_b32 v51, v32, v32, v19
    s_waitcnt vmcnt(11)
    v_mfma_f32_16x16x32_bf16 v[52:55], v[208:211], v[44:47], v[52:55]
    v_perm_b32 v44, v34, v34, v12
    v_perm_b32 v45, v34, v34, v13
    v_perm_b32 v46, v34, v34, v14
    v_perm_b32 v47, v34, v34, v15
    s_waitcnt vmcnt(10)
    v_mfma_f32_16x16x32_bf16 v[52:55], v[212:215], v[48:51], v[52:55]
    v_perm_b32 v48, v34, v34, v16
    v_perm_b32 v49, v34, v34, v17
    v_perm_b32 v50, v34, v34, v18
    v_perm_b32 v51, v34, v34, v19
    s_waitcnt vmcnt(9)
    v_mfma_f32_16x16x32_bf16 v[52:55], v[216:219], v[44:47], v[52:55]
    v_perm_b32 v44, v36, v36, v12
    v_perm_b32 v45, v36, v36, v13
    v_perm_b32 v46, v36, v36, v14
    v_perm_b32 v47, v36, v36, v15
    s_waitcnt vmcnt(8)
    v_mfma_f32_16x16x32_bf16 v[52:55], v[220:223], v[48:51], v[52:55]
    v_perm_b32 v48, v36, v36, v16
    v_perm_b32 v49, v36, v36, v17
    v_perm_b32 v50, v36, v36, v18
    v_perm_b32 v51, v36, v36, v19
    s_waitcnt vmcnt(7)
    v_mfma_f32_16x16x32_bf16 v[52:55], v[224:227], v[44:47], v[52:55]
    v_perm_b32 v44, v38, v38, v12
    v_perm_b32 v45, v38, v38, v13
    v_perm_b32 v46, v38, v38, v14
    v_perm_b32 v47, v38, v38, v15
    s_waitcnt vmcnt(6)
    v_mfma_f32_16x16x32_bf16 v[52:55], v[228:231], v[48:51], v[52:55]
    v_perm_b32 v48, v38, v38, v16
    v_perm_b32 v49, v38, v38, v17
    v_perm_b32 v50, v38, v38, v18
    v_perm_b32 v51, v38, v38, v19
    s_waitcnt vmcnt(5)
    v_mfma_f32_16x16x32_bf16 v[52:55], v[232:235], v[44:47], v[52:55]
    v_perm_b32 v44, v40, v40, v12
    v_perm_b32 v45, v40, v40, v13
    v_perm_b32 v46, v40, v40, v14
    v_perm_b32 v47, v40, v40, v15
    s_waitcnt vmcnt(4)
    v_mfma_f32_16x16x32_bf16 v[52:55], v[236:239], v[48:51], v[52:55]
    v_perm_b32 v48, v40, v40, v16
    v_perm_b32 v49, v40, v40, v17
    v_perm_b32 v50, v40, v40, v18
    v_perm_b32 v51, v40, v40, v19
    s_waitcnt vmcnt(3)
    v_mfma_f32_16x16x32_bf16 v[52:55], v[240:243], v[44:47], v[52:55]
    v_perm_b32 v44, v42, v42, v12
    v_perm_b32 v45, v42, v42, v13
    v_perm_b32 v46, v42, v42, v14
    v_perm_b32 v47, v42, v42, v15
    s_waitcnt vmcnt(2)
    v_mfma_f32_16x16x32_bf16 v[52:55], v[244:247], v[48:51], v[52:55]
    v_perm_b32 v48, v42, v42, v16
    v_perm_b32 v49, v42, v42, v17
    v_perm_b32 v50, v42, v42, v18
    v_perm_b32 v51, v42, v42, v19
    s_waitcnt vmcnt(1)
    v_mfma_f32_16x16x32_bf16 v[52:55], v[248:251], v[44:47], v[52:55]
    s_nop 1
    s_waitcnt vmcnt(0)
    v_mfma_f32_16x16x32_bf16 v[52:55], v[252:255], v[48:51], v[52:55]
    s_branch L_tail
L_tail:
    v_lshlrev_b32 v4, 5, v3
    v_add_u32 v4, v4, v2
    v_lshlrev_b32 v4, 2, v4
    s_mul_i32 s76, s11, 528
    v_add_u32 v4, s76, v4
    s_nop 4
    s_mov_b64 exec, s[80:81]
    ds_write_b32 v4, v52 offset:4608
    ds_write_b32 v4, v53 offset:4640
    ds_write_b32 v4, v54 offset:4672
    ds_write_b32 v4, v55 offset:4704
    s_mov_b64 exec, -1
    s_cmp_lg_u32 s11, 7
    s_cbranch_scc1 L_nomlst
    v_lshlrev_b32 v9, 12, v1
    s_lshl_b32 s76, s10, 4
    s_add_u32 s76, s76, 655360
    s_mov_b64 exec, 31
    buffer_store_dwordx4 v[72:75], v9, s[72:75], s76 offen sc1
    s_mov_b64 exec, -1
    L_nomlst:
L_nopre:
    s_waitcnt lgkmcnt(0)
    s_barrier
    ds_read_b32 v8, v68 offset:4608
    ds_read_b32 v9, v69 offset:4608
    ds_read_b32 v10, v70 offset:4608
    ds_read_b32 v11, v71 offset:4608
    s_waitcnt lgkmcnt(0)
    v_add_f32_dpp v8, v8, v8 quad_perm:[1,0,3,2] row_mask:0xf bank_mask:0xf
    v_add_f32_dpp v9, v9, v9 quad_perm:[1,0,3,2] row_mask:0xf bank_mask:0xf
    v_add_f32_dpp v10, v10, v10 quad_perm:[1,0,3,2] row_mask:0xf bank_mask:0xf
    v_add_f32_dpp v11, v11, v11 quad_perm:[1,0,3,2] row_mask:0xf bank_mask:0xf
    v_add_f32_dpp v8, v8, v8 quad_perm:[2,3,0,1] row_mask:0xf bank_mask:0xf
    v_add_f32_dpp v9, v9, v9 quad_perm:[2,3,0,1] row_mask:0xf bank_mask:0xf
    v_add_f32_dpp v10, v10, v10 quad_perm:[2,3,0,1] row_mask:0xf bank_mask:0xf
    v_add_f32_dpp v11, v11, v11 quad_perm:[2,3,0,1] row_mask:0xf bank_mask:0xf
    v_add_f32_dpp v8, v8, v8 row_half_mirror row_mask:0xf bank_mask:0xf
    v_add_f32_dpp v9, v9, v9 row_half_mirror row_mask:0xf bank_mask:0xf
    v_add_f32_dpp v10, v10, v10 row_half_mirror row_mask:0xf bank_mask:0xf
    v_add_f32_dpp v11, v11, v11 row_half_mirror row_mask:0xf bank_mask:0xf
    v_cvt_pk_bf16_f32 v8, v8, v9
    v_cvt_pk_bf16_f32 v10, v10, v11
    v_perm_b32 v20, v8, v8, v12
    v_perm_b32 v21, v8, v8, v13
    v_perm_b32 v22, v8, v8, v14
    v_perm_b32 v23, v8, v8, v15
    v_perm_b32 v24, v8, v8, v16
    v_perm_b32 v25, v8, v8, v17
    v_perm_b32 v26, v8, v8, v18
    v_perm_b32 v27, v8, v8, v19
    v_perm_b32 v28, v10, v10, v12
    v_perm_b32 v29, v10, v10, v13
    v_perm_b32 v30, v10, v10, v14
    v_perm_b32 v31, v10, v10, v15
    v_perm_b32 v32, v10, v10, v16
    v_perm_b32 v33, v10, v10, v17
    v_perm_b32 v34, v10, v10, v18
    v_perm_b32 v35, v10, v10, v19
    v_mfma_f32_16x16x32_bf16 v[36:39], v[80:83], v[20:23], 0
    v_mfma_f32_16x16x32_bf16 v[40:43], v[84:87], v[20:23], 0
    v_mfma_f32_16x16x32_bf16 v[44:47], v[88:91], v[20:23], 0
    v_mfma_f32_16x16x32_bf16 v[48:51], v[92:95], v[20:23], 0
    v_mfma_f32_16x16x32_bf16 v[52:55], v[96:99], v[20:23], 0
    v_mfma_f32_16x16x32_bf16 v[36:39], v[100:103], v[24:27], v[36:39]
    v_mfma_f32_16x16x32_bf16 v[40:43], v[104:107], v[24:27], v[40:43]
    v_mfma_f32_16x16x32_bf16 v[44:47], v[108:111], v[24:27], v[44:47]
    v_mfma_f32_16x16x32_bf16 v[48:51], v[112:115], v[24:27], v[48:51]
    v_mfma_f32_16x16x32_bf16 v[52:55], v[116:119], v[24:27], v[52:55]
    v_mfma_f32_16x16x32_bf16 v[36:39], v[120:123], v[28:31], v[36:39]
    v_mfma_f32_16x16x32_bf16 v[40:43], v[124:127], v[28:31], v[40:43]
    v_mfma_f32_16x16x32_bf16 v[44:47], v[128:131], v[28:31], v[44:47]
    v_mfma_f32_16x16x32_bf16 v[48:51], v[132:135], v[28:31], v[48:51]
    v_mfma_f32_16x16x32_bf16 v[52:55], v[136:139], v[28:31], v[52:55]
    v_mfma_f32_16x16x32_bf16 v[36:39], v[140:143], v[32:35], v[36:39]
    v_mfma_f32_16x16x32_bf16 v[40:43], v[144:147], v[32:35], v[40:43]
    v_mfma_f32_16x16x32_bf16 v[44:47], v[148:151], v[32:35], v[44:47]
    v_mfma_f32_16x16x32_bf16 v[48:51], v[152:155], v[32:35], v[48:51]
    v_mfma_f32_16x16x32_bf16 v[52:55], v[156:159], v[32:35], v[52:55]
    v_lshlrev_b32 v4, 3, v3
    v_add_u32 v4, v4, v2
    v_lshlrev_b32 v4, 4, v4
    s_mul_i32 s76, s11, 2560
    v_add_u32 v4, s76, v4
    s_nop 4
    s_mov_b64 exec, s[80:81]
    ds_write_b128 v4, v[36:39] offset:8960
    ds_write_b128 v4, v[40:43] offset:9472
    ds_write_b128 v4, v[44:47] offset:9984
    ds_write_b128 v4, v[48:51] offset:10496
    ds_write_b128 v4, v[52:55] offset:11008
    s_mov_b64 exec, -1
    s_waitcnt lgkmcnt(0)
    s_barrier
    s_cmp_gt_u32 s11, 2
    s_cbranch_scc1 L_after_store
    v_cmp_gt_u32 vcc, 160, v0
    s_and_saveexec_b64 s[86:87], vcc
    s_cbranch_execz L_tail_y_done
    v_lshlrev_b32 v4, 4, v0
    v_lshrrev_b32 v5, 2, v0
    v_and_b32 v6, 3, v0
    v_lshlrev_b32 v6, 4, v6
    v_lshl_add_u32 v5, v5, 14, v6
    ds_read_b128 v[20:23], v4 offset:8960
    ds_read_b128 v[24:27], v4 offset:11520
    ds_read_b128 v[28:31], v4 offset:14080
    ds_read_b128 v[32:35], v4 offset:16640
    ds_read_b128 v[36:39], v4 offset:19200
    ds_read_b128 v[40:43], v4 offset:21760
    ds_read_b128 v[44:47], v4 offset:24320
    ds_read_b128 v[48:51], v4 offset:26880
    s_waitcnt lgkmcnt(0)
    v_add_f32 v20, v20, v24
    v_add_f32 v28, v28, v32
    v_add_f32 v36, v36, v40
    v_add_f32 v44, v44, v48
    v_add_f32 v21, v21, v25
    v_add_f32 v29, v29, v33
    v_add_f32 v37, v37, v41
    v_add_f32 v45, v45, v49
    v_add_f32 v22, v22, v26
    v_add_f32 v30, v30, v34
    v_add_f32 v38, v38, v42
    v_add_f32 v46, v46, v50
    v_add_f32 v23, v23, v27
    v_add_f32 v31, v31, v35
    v_add_f32 v39, v39, v43
    v_add_f32 v47, v47, v51
    v_add_f32 v20, v20, v28
    v_add_f32 v36, v36, v44
    v_add_f32 v21, v21, v29
    v_add_f32 v37, v37, v45
    v_add_f32 v22, v22, v30
    v_add_f32 v38, v38, v46
    v_add_f32 v23, v23, v31
    v_add_f32 v39, v39, v47
    v_add_f32 v20, v20, v36
    v_add_f32 v21, v21, v37
    v_add_f32 v22, v22, v38
    v_add_f32 v23, v23, v39
    v_mov_b32 v11, 0xfff
    v_bfi_b32 v20, v11, s94, v20
    v_bfi_b32 v21, v11, s95, v21
    v_bfi_b32 v22, v11, s96, v22
    v_bfi_b32 v23, v11, s98, v23
    s_lshl_b32 s76, s10, 6
    buffer_store_dwordx4 v[20:23], v5, s[72:75], s76 offen sc1
L_tail_y_done:
    s_mov_b64 exec, s[86:87]
L_after_store:
    s_cmp_ge_u32 s99, 40
    s_cbranch_scc1 L_end
L_clr_ok:
    v_lshlrev_b32 v4, 4, v0
    v_lshlrev_b32 v12, 4, v0
    s_lshl_b32 s78, s99, 14
    s_add_u32 s79, s78, 8192
    s_cmp_gt_u32 s11, 3
    s_cbranch_scc1 L_ml_done
    v_lshlrev_b32 v9, 3, v0
    s_mul_i32 s76, s99, 52
    s_lshr_b32 s76, s76, 8
    s_mul_i32 s76, s76, 5
    s_sub_u32 s76, s99, s76
    s_lshl_b32 s76, s76, 12
    s_add_u32 s77, s76, 655360
    s_mov_b64 s[44:45], exec
    s_mov_b64 s[46:47], s[44:45]
    buffer_load_dwordx4 v[160:163], v12, s[72:75], s77 offen sc1
L_mlp_loop:
    s_waitcnt vmcnt(0)
    s_and_b64 exec, s[46:47], s[44:45]
    v_xor_b32 v7, s42, v162
    v_xor_b32 v8, s43, v163
    v_or_b32 v7, v7, v8
    v_cmp_ne_u32 vcc, 0, v7
    s_andn2_b64 exec, exec, vcc
    ds_write_b64 v9, v[160:161] offset:29440
    s_andn2_b64 s[44:45], s[44:45], exec
    s_cbranch_scc0 L_mlp_done
    s_mov_b64 exec, s[44:45]
    s_mov_b64 s[46:47], s[44:45]
    buffer_load_dwordx4 v[160:163], v12, s[72:75], s77 offen sc1
    s_branch L_mlp_loop
L_mlp_done:
    s_mov_b64 exec, -1
    s_waitcnt lgkmcnt(0)
L_ml_done:
    s_barrier
    s_mov_b64 s[44:45], exec
    s_mov_b64 s[46:47], s[44:45]
    buffer_load_dwordx4 v[176:179], v4, s[72:75], s78 offen sc1
    buffer_load_dwordx4 v[180:183], v4, s[72:75], s79 offen sc1
    v_lshrrev_b32 v10, 2, v0
    v_add_u32 v11, 128, v10
    v_mul_u32_u24 v6, 171, v10
    v_lshrrev_b32 v6, 10, v6
    v_mul_u32_u24 v6, 48, v6
    v_lshlrev_b32 v7, 3, v10
    ds_read_b128 v[28:31], v6 offset:29440
    ds_read_b128 v[32:35], v6 offset:29456
    ds_read_b128 v[36:39], v6 offset:29472
    ds_read_b32 v24, v7 offset:29440
    s_waitcnt lgkmcnt(0)
    v_max3_f32 v7, v28, v30, v32
    v_max3_f32 v7, v7, v34, v36
    v_max_f32 v7, v7, v38
    v_sub_f32 v28, v28, v7
    v_sub_f32 v30, v30, v7
    v_sub_f32 v32, v32, v7
    v_sub_f32 v34, v34, v7
    v_sub_f32 v36, v36, v7
    v_sub_f32 v38, v38, v7
    v_sub_f32 v24, v24, v7
    v_exp_f32 v28, v28
    v_exp_f32 v30, v30
    v_exp_f32 v32, v32
    v_exp_f32 v34, v34
    v_exp_f32 v36, v36
    v_exp_f32 v38, v38
    v_exp_f32 v24, v24
    s_nop 0
    v_mul_f32 v8, v28, v29
    v_fmac_f32 v8, v30, v31
    v_fmac_f32 v8, v32, v33
    v_fmac_f32 v8, v34, v35
    v_fmac_f32 v8, v36, v37
    v_fmac_f32 v8, v38, v39
    v_rcp_f32 v8, v8
    s_nop 0
    v_mul_f32 v74, v24, v8
    s_cmp_gt_u32 s11, 3
    s_cbranch_scc1 L_wA
    v_mul_u32_u24 v6, 171, v11
    v_lshrrev_b32 v6, 10, v6
    v_mul_u32_u24 v6, 48, v6
    v_lshlrev_b32 v7, 3, v11
    ds_read_b128 v[28:31], v6 offset:29440
    ds_read_b128 v[32:35], v6 offset:29456
    ds_read_b128 v[36:39], v6 offset:29472
    ds_read_b32 v24, v7 offset:29440
    s_waitcnt lgkmcnt(0)
    v_max3_f32 v7, v28, v30, v32
    v_max3_f32 v7, v7, v34, v36
    v_max_f32 v7, v7, v38
    v_sub_f32 v28, v28, v7
    v_sub_f32 v30, v30, v7
    v_sub_f32 v32, v32, v7
    v_sub_f32 v34, v34, v7
    v_sub_f32 v36, v36, v7
    v_sub_f32 v38, v38, v7
    v_sub_f32 v24, v24, v7
    v_exp_f32 v28, v28
    v_exp_f32 v30, v30
    v_exp_f32 v32, v32
    v_exp_f32 v34, v34
    v_exp_f32 v36, v36
    v_exp_f32 v38, v38
    v_exp_f32 v24, v24
    s_nop 0
    v_mul_f32 v8, v28, v29
    v_fmac_f32 v8, v30, v31
    v_fmac_f32 v8, v32, v33
    v_fmac_f32 v8, v34, v35
    v_fmac_f32 v8, v36, v37
    v_fmac_f32 v8, v38, v39
    v_rcp_f32 v8, v8
    s_nop 0
    v_mul_f32 v75, v24, v8
    s_branch L_wdone
L_wA:
    v_and_b32 v6, 0x1fe, v11
    v_lshlrev_b32 v6, 3, v6
    v_lshlrev_b32 v7, 3, v11
    ds_read_b128 v[28:31], v6 offset:29440
    ds_read_b32 v24, v7 offset:29440
    s_waitcnt lgkmcnt(0)
    v_max_f32 v7, v28, v30
    v_sub_f32 v28, v28, v7
    v_sub_f32 v30, v30, v7
    v_sub_f32 v24, v24, v7
    v_exp_f32 v28, v28
    v_exp_f32 v30, v30
    v_exp_f32 v24, v24
    s_nop 0
    v_mul_f32 v8, v28, v29
    v_fmac_f32 v8, v30, v31
    v_rcp_f32 v8, v8
    s_nop 0
    v_mul_f32 v75, v24, v8
L_wdone:
L_yp_loop:
    s_waitcnt vmcnt(0)
    s_and_b64 exec, s[46:47], s[44:45]
    v_xor_b32 v24, s94, v176
    v_xor_b32 v25, s95, v177
    v_xor_b32 v26, s96, v178
    v_xor_b32 v27, s98, v179
    v_or3_b32 v7, v24, v25, v26
    v_or_b32 v7, v7, v27
    v_xor_b32 v24, s94, v180
    v_xor_b32 v25, s95, v181
    v_xor_b32 v26, s96, v182
    v_xor_b32 v27, s98, v183
    v_or3_b32 v7, v7, v24, v25
    v_or3_b32 v7, v7, v26, v27
    v_and_b32 v7, 0xfff, v7
    v_cmp_ne_u32 vcc, 0, v7
    s_andn2_b64 exec, exec, vcc
    v_mul_f32 v56, v176, v74
    v_mul_f32 v57, v177, v74
    v_mul_f32 v58, v178, v74
    v_mul_f32 v59, v179, v74
    v_mul_f32 v60, v180, v75
    v_mul_f32 v61, v181, v75
    v_mul_f32 v62, v182, v75
    v_mul_f32 v63, v183, v75
    s_andn2_b64 s[44:45], s[44:45], exec
    s_cbranch_scc0 L_yp_done
    s_mov_b64 exec, s[44:45]
    s_mov_b64 s[46:47], s[44:45]
    buffer_load_dwordx4 v[176:179], v4, s[72:75], s78 offen sc1
    buffer_load_dwordx4 v[180:183], v4, s[72:75], s79 offen sc1
    s_branch L_yp_loop
L_yp_done:
    s_mov_b64 exec, -1
L_gotY:
    v_mov_b32 v20, v56
    v_mov_b32 v21, v57
    v_mov_b32 v22, v58
    v_mov_b32 v23, v59
    v_mov_b32 v24, v60
    v_mov_b32 v25, v61
    v_mov_b32 v26, v62
    v_mov_b32 v27, v63
    s_cmp_gt_u32 s11, 3
    s_cbranch_scc1 L_redA
    v_add_f32 v20, v20, v24
    v_add_f32 v21, v21, v25
    v_add_f32 v22, v22, v26
    v_add_f32 v23, v23, v27
    s_nop 1
    v_add_f32_dpp v20, v20, v20 row_shr:4 row_mask:0xf bank_mask:0xf bound_ctrl:0
    v_add_f32_dpp v21, v21, v21 row_shr:4 row_mask:0xf bank_mask:0xf bound_ctrl:0
    v_add_f32_dpp v22, v22, v22 row_shr:4 row_mask:0xf bank_mask:0xf bound_ctrl:0
    v_add_f32_dpp v23, v23, v23 row_shr:4 row_mask:0xf bank_mask:0xf bound_ctrl:0
    v_add_f32_dpp v20, v20, v20 row_shr:8 row_mask:0xf bank_mask:0xf bound_ctrl:0
    v_add_f32_dpp v21, v21, v21 row_shr:8 row_mask:0xf bank_mask:0xf bound_ctrl:0
    v_add_f32_dpp v22, v22, v22 row_shr:8 row_mask:0xf bank_mask:0xf bound_ctrl:0
    v_add_f32_dpp v23, v23, v23 row_shr:8 row_mask:0xf bank_mask:0xf bound_ctrl:0
    s_branch L_redW
L_redA:
    v_add_f32_dpp v20, v20, v20 row_shr:4 row_mask:0xf bank_mask:0xf bound_ctrl:0
    v_add_f32_dpp v21, v21, v21 row_shr:4 row_mask:0xf bank_mask:0xf bound_ctrl:0
    v_add_f32_dpp v22, v22, v22 row_shr:4 row_mask:0xf bank_mask:0xf bound_ctrl:0
    v_add_f32_dpp v23, v23, v23 row_shr:4 row_mask:0xf bank_mask:0xf bound_ctrl:0
    v_add_f32_dpp v24, v24, v24 row_shr:4 row_mask:0xf bank_mask:0xf bound_ctrl:0
    v_add_f32_dpp v25, v25, v25 row_shr:4 row_mask:0xf bank_mask:0xf bound_ctrl:0
    v_add_f32_dpp v26, v26, v26 row_shr:4 row_mask:0xf bank_mask:0xf bound_ctrl:0
    v_add_f32_dpp v27, v27, v27 row_shr:4 row_mask:0xf bank_mask:0xf bound_ctrl:0
    v_add_f32_dpp v20, v20, v20 row_shr:8 row_mask:0xf bank_mask:0xf bound_ctrl:0
    v_add_f32_dpp v21, v21, v21 row_shr:8 row_mask:0xf bank_mask:0xf bound_ctrl:0
    v_add_f32_dpp v22, v22, v22 row_shr:8 row_mask:0xf bank_mask:0xf bound_ctrl:0
    v_add_f32_dpp v23, v23, v23 row_shr:8 row_mask:0xf bank_mask:0xf bound_ctrl:0
    v_add_f32_dpp v24, v24, v24 row_shr:8 row_mask:0xf bank_mask:0xf bound_ctrl:0
    v_add_f32_dpp v25, v25, v25 row_shr:8 row_mask:0xf bank_mask:0xf bound_ctrl:0
    v_add_f32_dpp v26, v26, v26 row_shr:8 row_mask:0xf bank_mask:0xf bound_ctrl:0
    v_add_f32_dpp v27, v27, v27 row_shr:8 row_mask:0xf bank_mask:0xf bound_ctrl:0
L_redW:
    v_and_b32 v5, 3, v1
    v_mul_u32_u24 v5, 576, v5
    v_lshl_add_u32 v5, v3, 2, v5
    s_lshl_b32 s76, s11, 4
    v_add_u32 v5, s76, v5
    s_mov_b32 s78, 0xf000f000
    s_mov_b32 s79, 0xf000f000
    s_mov_b64 exec, s[78:79]
    ds_write_b32 v5, v20 offset:31488
    ds_write_b32 v5, v21 offset:31632
    ds_write_b32 v5, v22 offset:31776
    ds_write_b32 v5, v23 offset:31920
    s_cmp_lt_u32 s11, 4
    s_cbranch_scc1 L_noA
    v_and_b32 v6, 3, v1
    v_mul_u32_u24 v6, 320, v6
    v_lshl_add_u32 v6, v3, 2, v6
    s_lshl_b32 s76, s11, 4
    s_sub_u32 s76, s76, 64
    v_add_u32 v6, s76, v6
    ds_write_b32 v6, v24 offset:33792
    ds_write_b32 v6, v25 offset:33872
    ds_write_b32 v6, v26 offset:33952
    ds_write_b32 v6, v27 offset:34032
L_noA:
    s_mov_b64 exec, -1
    s_waitcnt lgkmcnt(0)
    s_barrier
    s_cmp_lg_u32 s11, 2
    s_cbranch_scc1 L_noeupd
    s_cmp_lg_u32 s99, 0
    s_cbranch_scc1 L_noeupd
    v_mov_b32 v4, s42
    v_mov_b32 v5, 0
    s_mov_b32 s76, 950272
    s_mov_b64 exec, 1
    buffer_store_dword v4, v5, s[72:75], s76 offen sc1
    s_mov_b64 exec, -1
    L_noeupd:
    s_cmp_gt_u32 s11, 1
    s_cbranch_scc1 L_end
    s_mov_b32 s88, s36
    s_mov_b32 s89, s37
    s_mov_b32 s90, 2560
    s_mov_b32 s91, 0x00020000
    v_lshrrev_b32 v5, 2, v1
    v_and_b32 v6, 3, v1
    s_cmp_eq_u32 s11, 1
    s_cbranch_scc1 L_finA
    v_mul_u32_u24 v4, 144, v5
    v_lshl_add_u32 v4, v6, 5, v4
    ds_read_b128 v[20:23], v4 offset:31488
    ds_read_b128 v[24:27], v4 offset:31504
    s_movk_i32 s79, 1280
    v_lshrrev_b32 v8, 2, v5
    s_lshl_b32 s76, s99, 2
    v_add_u32 v8, s76, v8
    v_lshrrev_b32 v9, 5, v8
    v_lshlrev_b32 v9, 7, v9
    v_bfe_u32 v7, v8, 3, 2
    v_lshl_add_u32 v9, v7, 5, v9
    v_and_b32 v7, 7, v8
    v_add_u32 v9, v9, v7
    v_and_b32 v7, 3, v5
    v_lshl_add_u32 v9, v7, 3, v9
    v_lshlrev_b32 v9, 1, v9
    s_waitcnt lgkmcnt(0)
    v_add_f32 v20, v20, v21
    v_add_f32 v22, v22, v23
    v_add_f32 v24, v24, v25
    v_add_f32 v26, v26, v27
    v_add_f32 v20, v20, v22
    v_add_f32 v24, v24, v26
    v_add_f32 v20, v20, v24
    s_branch L_fsum
L_finA:
    v_mul_u32_u24 v4, 80, v5
    v_lshl_add_u32 v4, v6, 4, v4
    ds_read_b128 v[20:23], v4 offset:33792
    s_movk_i32 s79, 0
    v_lshrrev_b32 v8, 2, v5
    s_lshl_b32 s76, s99, 2
    v_add_u32 v8, s76, v8
    v_lshrrev_b32 v9, 5, v8
    v_lshlrev_b32 v9, 7, v9
    v_bfe_u32 v7, v8, 3, 2
    v_lshl_add_u32 v9, v7, 5, v9
    v_and_b32 v7, 7, v8
    v_add_u32 v9, v9, v7
    v_and_b32 v7, 3, v5
    v_lshl_add_u32 v9, v7, 3, v9
    v_lshlrev_b32 v9, 1, v9
    s_waitcnt lgkmcnt(0)
    v_add_f32 v20, v20, v21
    v_add_f32 v22, v22, v23
    v_add_f32 v20, v20, v22
L_fsum:
    s_nop 1
    v_add_f32_dpp v20, v20, v20 quad_perm:[1,0,3,2] row_mask:0xf bank_mask:0xf
    s_nop 1
    v_add_f32_dpp v20, v20, v20 quad_perm:[2,3,0,1] row_mask:0xf bank_mask:0xf
    s_mov_b32 s76, 0x11111111
    s_mov_b32 s77, 0x11111111
    s_mov_b64 exec, s[76:77]
    v_cvt_pk_bf16_f32 v20, v20, v20
    buffer_store_short v20, v9, s[88:91], s79 offen
L_end:
L_end2:
    s_endpgm
.section .rodata,"a"
.p2align 6
.amdhsa_kernel concat_heads__sliding_block_cached__gqa_block_cached__decode_kernel
  .amdhsa_next_free_vgpr 256
  .amdhsa_next_free_sgpr 102
  .amdhsa_accum_offset 256
  .amdhsa_group_segment_fixed_size 0
  .amdhsa_kernarg_size 104
  .amdhsa_user_sgpr_count 2
  .amdhsa_user_sgpr_kernarg_segment_ptr 1
  .amdhsa_system_sgpr_workgroup_id_x 1
.end_amdhsa_kernel
```
